```python
import torch

def _softmax(x, axis=-1):
    return torch.softmax(x, dim=axis)
def _gelu(x):
    return torch.nn.functional.gelu(x, approximate="tanh")
def _silu(x):
    return torch.nn.functional.silu(x)
def _sigmoid(x):
    return torch.sigmoid(x)
def _layernorm(x, axis=-1, eps=1e-5):
    m = x.mean(dim=axis, keepdim=True)
    v = x.var(dim=axis, keepdim=True, unbiased=False)
    return (x - m) / torch.sqrt(v + eps)
def _scatter_add(tgt, idx, src, axis=0):
    return tgt.clone().index_add_(axis, idx, src)
def _segment_sum(src, seg, n):
    out = torch.zeros((n,) + src.shape[1:], dtype=src.dtype)
    return out.index_add_(0, seg, src)
def _pad(x, pw):
    flat = tuple(v for pair in reversed(pw) for v in pair)
    return torch.nn.functional.pad(x, flat)

kernel_name = 'parallel_sum__ssm_conv_s5__glu_gated_glu__prompt'

def setup_inputs():

    _w = (lambda a: (lambda t: t.to(torch.bfloat16) if t.is_floating_point() else t)(torch.as_tensor(a)))
    def _A_setup():
        B, S, D = 1, 2048, 512
        P = D
        Lambda_re = -0.5 * (lambda _x: torch.exp(torch.as_tensor(_x)))((lambda *s: torch.randn(*s, dtype=torch.bfloat16) * 0.8)(P))
        Lambda_im = (lambda *s: torch.randn(*s, dtype=torch.bfloat16) * 0.8)(P) * 1.0
        B_re = (lambda *s: torch.randn(*s, dtype=torch.bfloat16) * 0.8)(P, D) * (D ** -0.5)
        B_im = (lambda *s: torch.randn(*s, dtype=torch.bfloat16) * 0.8)(P, D) * (D ** -0.5)
        C_re = (lambda *s: torch.randn(*s, dtype=torch.bfloat16) * 0.8)(D, P) * (P ** -0.5)
        C_im = (lambda *s: torch.randn(*s, dtype=torch.bfloat16) * 0.8)(D, P) * (P ** -0.5)
        log_dt = (lambda *s: torch.randn(*s, dtype=torch.bfloat16) * 0.8)(P) * 0.3 - 2.0
        Dskip = (lambda *s: torch.randn(*s, dtype=torch.bfloat16) * 0.8)(D)
        return {
            "x": _w((lambda *s: torch.randn(*s, dtype=torch.bfloat16) * 0.05)(B, S, D)),
            "Lambda_re": _w(Lambda_re),
            "Lambda_im": _w(Lambda_im),
            "B_re": _w(B_re),
            "B_im": _w(B_im),
            "C_re": _w(C_re),
            "C_im": _w(C_im),
            "log_dt": _w(log_dt),
            "Dskip": _w(Dskip),
        }
    _A_in = _A_setup()

    def _B_setup():
        B, S, D, F = 1, 2048, 512, 1792
        return {
            "x": _w((lambda *s: torch.randn(*s, dtype=torch.bfloat16) * 0.05)(B, S, D)),
            "w_gate": _w((lambda *s: torch.randn(*s, dtype=torch.bfloat16) * 0.05)(D, F)),
            "w_up": _w((lambda *s: torch.randn(*s, dtype=torch.bfloat16) * 0.05)(D, F)),
            "w_down": _w((lambda *s: torch.randn(*s, dtype=torch.bfloat16) * 0.05)(F, D)),
        }
    _B_in = _B_setup()

    return {
        "A_x": _A_in["x"],
        "A_Lambda_re": _A_in["Lambda_re"],
        "A_Lambda_im": _A_in["Lambda_im"],
        "A_B_re": _A_in["B_re"],
        "A_B_im": _A_in["B_im"],
        "A_C_re": _A_in["C_re"],
        "A_C_im": _A_in["C_im"],
        "A_log_dt": _A_in["log_dt"],
        "A_Dskip": _A_in["Dskip"],
        "B_x": _B_in["x"],
        "B_w_gate": _B_in["w_gate"],
        "B_w_up": _B_in["w_up"],
        "B_w_down": _B_in["w_down"],
    }

def reference(A_x, A_Lambda_re, A_Lambda_im, A_B_re, A_B_im, A_C_re, A_C_im, A_log_dt, A_Dskip, B_x, B_w_gate, B_w_up, B_w_down):
    def _A_ref(x, Lambda_re, Lambda_im, B_re, B_im, C_re, C_im, log_dt, Dskip):
        Bsz, L, H = x.shape
        Lam = Lambda_re + 1j * Lambda_im
        Bmat = B_re + 1j * B_im
        Cmat = C_re + 1j * C_im
        dt = torch.exp(log_dt)
        Lam_bar = torch.exp(dt * Lam)
        B_bar = ((Lam_bar - 1.0) / Lam)[:, None] * Bmat
        Bu = torch.einsum("bld,pd->blp", x + 0j, B_bar)
        h = torch.zeros_like(Bu[:, 0, :])
        hs = []
        for t in range(L):
            h = Lam_bar[None, :] * h + Bu[:, t, :]
            hs.append(h)
        hseq = torch.stack(hs, 1)
        y = 2.0 * torch.einsum("blp,dp->bld", hseq, Cmat).real + x * Dskip[None, None, :]
        return y

    def _B_ref(x, w_gate, w_up, w_down):
        g = torch.einsum("bsd,df->bsf", x, w_gate)
        u = torch.einsum("bsd,df->bsf", x, w_up)
        h = _sigmoid(g) * u
        return torch.einsum("bsf,fd->bsd", h, w_down)

    x = A_x
    xn = _layernorm(x, axis=-1)
    return x + _A_ref(xn, A_Lambda_re, A_Lambda_im, A_B_re, A_B_im, A_C_re, A_C_im, A_log_dt, A_Dskip) + _B_ref(xn, B_w_gate, B_w_up, B_w_down)
```

```asm
; @launch grid=(256,1,1) block=(256,1,1) lds=163840
.amdgcn_target "amdgcn-amd-amdhsa--gfx950"
.text
.globl parallel_sum__ssm_conv_s5__glu_gated_glu__prompt_kernel
.p2align 8
.type parallel_sum__ssm_conv_s5__glu_gated_glu__prompt_kernel,@function
parallel_sum__ssm_conv_s5__glu_gated_glu__prompt_kernel:
k_start:
    s_cmp_ge_u32 s2, 256
    s_cbranch_scc1 k_exit
    s_load_dwordx2 s[4:5], s[0:1], 0
    s_load_dwordx2 s[8:9], s[0:1], 24
    s_load_dwordx2 s[12:13], s[0:1], 32
    v_lshrrev_b32 v224, 6, v0
    v_and_b32 v223, 63, v0
    v_readfirstlane_b32 s62, v224
    s_and_b32 s67, s2, 7
    s_lshr_b32 s76, s2, 3
    s_and_b32 s63, s67, 3
    s_lshl_b32 s63, s63, 2
    s_and_b32 s77, s76, 3
    s_add_u32 s63, s63, s77
    s_lshr_b32 s76, s76, 2
    s_lshr_b32 s64, s67, 2
    s_lshl_b32 s64, s64, 3
    s_add_u32 s64, s64, s76
    s_and_b32 s65, s64, 3
    s_lshl_b32 s66, s64, 1
    s_add_u32 s66, s66, s63
    s_lshl_b32 s66, s66, 7
    s_and_b32 s68, s66, 0x380
    v_lshrrev_b32 v225, 3, v223
    v_and_b32 v226, 7, v223
    v_lshrrev_b32 v227, 1, v225
    v_xor_b32 v227, v226, v227
    v_lshlrev_b32 v227, 4, v227
    v_lshrrev_b32 v228, 2, v225
    v_lshlrev_b32 v228, 4, v228
    v_and_b32 v229, 3, v225
    v_add_u32 v228, v228, v229
    v_lshl_add_u32 v189, v228, 10, v227
    v_xor_b32 v190, 64, v189
    v_add_u32 v191, 6144, v189
    v_add_u32 v192, 9216, v190
    v_add_u32 v190, 3072, v190
    s_lshl_b32 s82, s62, 12
    s_lshl_b32 s79, s63, 17
    s_lshl_b32 s67, s62, 15
    s_add_u32 s79, s79, s67
    s_mov_b32 s6, 2097152
    s_mov_b32 s7, 0x20000
    s_add_u32 m0, s82, 0
    s_add_u32 s92, s79, s68
    s_waitcnt lgkmcnt(0)
    buffer_load_dwordx4 v189, s[4:7], s92 offen offset:0 lds
    buffer_load_dwordx4 v190, s[4:7], s92 offen offset:1024 lds
    buffer_load_dwordx4 v191, s[4:7], s92 offen offset:2048 lds
    buffer_load_dwordx4 v192, s[4:7], s92 offen offset:3072 lds
    s_load_dwordx2 s[52:53], s[0:1], 8
    s_load_dwordx2 s[54:55], s[0:1], 16
    s_load_dwordx2 s[56:57], s[0:1], 56
    s_load_dwordx2 s[20:21], s[0:1], 96
    s_load_dwordx2 s[16:17], s[0:1], 80
    s_load_dwordx2 s[60:61], s[0:1], 88
    s_load_dwordx2 s[24:25], s[0:1], 120
    s_load_dwordx2 s[36:37], s[0:1], 40
    s_load_dwordx2 s[40:41], s[0:1], 48
    s_load_dwordx2 s[44:45], s[0:1], 104
    s_lshl_b32 s80, s64, 15
    s_lshl_b32 s67, s62, 13
    s_add_u32 s80, s80, s67
    s_and_b32 s67, s62, 1
    s_lshl_b32 s67, s67, 6
    v_xor_b32 v193, s67, v227
    v_lshl_add_u32 v193, v225, 10, v193
    s_mov_b32 s10, 524288
    s_mov_b32 s11, 0x20000
    s_mov_b32 s14, 524288
    s_mov_b32 s15, 0x20000
    s_add_u32 m0, s82, 131072
    s_add_u32 s92, s80, s68
    buffer_load_dwordx4 v193, s[8:11], s92 offen lds
    s_add_u32 m0, s82, 132096
    s_nop 0
    buffer_load_dwordx4 v193, s[12:15], s92 offen lds
    s_getpc_b64 s[48:49]
Lpc0:
    s_sub_u32 s48, s48, Lpc0-k_start
    s_subb_u32 s49, s49, 0
    s_mov_b32 s50, k_all_end-k_start
    s_mov_b32 s51, 0x20000
    s_lshr_b32 s67, s2, 3
    s_and_b32 s67, s67, 31
    s_lshl_b32 s67, s67, 10
    v_lshlrev_b32 v231, 2, v0
    buffer_load_dword a255, v231, s[48:51], s67 offen
    s_add_u32 s67, s66, 128
    s_and_b32 s69, s67, 0x380
    s_add_u32 s67, s66, 256
    s_and_b32 s70, s67, 0x380
    s_add_u32 s67, s66, 384
    s_and_b32 s71, s67, 0x380
    s_add_u32 s67, s66, 512
    s_and_b32 s72, s67, 0x380
    s_add_u32 s67, s66, 640
    s_and_b32 s73, s67, 0x380
    s_add_u32 s67, s66, 768
    s_and_b32 s74, s67, 0x380
    s_add_u32 s67, s66, 896
    s_and_b32 s75, s67, 0x380
    v_and_b32 v222, 31, v223
    v_lshlrev_b32 v230, 1, v222
    s_lshl_b32 s76, s64, 6
    v_add_u32 v230, s76, v230
    s_waitcnt lgkmcnt(0)
    s_add_u32 s24, s24, 0
    s_addc_u32 s25, s25, 0
    s_add_u32 s100, s24, 15958016
    s_addc_u32 s101, s25, 0
    s_load_dword s99, s[100:101], 0
    global_load_ushort v232, v230, s[52:53]
    global_load_ushort v233, v230, s[54:55]
    global_load_ushort v234, v230, s[56:57]
    s_add_u32 m0, s82, 16384
    s_add_u32 s92, s79, s69
    buffer_load_dwordx4 v189, s[4:7], s92 offen offset:0 lds
    buffer_load_dwordx4 v190, s[4:7], s92 offen offset:1024 lds
    buffer_load_dwordx4 v191, s[4:7], s92 offen offset:2048 lds
    buffer_load_dwordx4 v192, s[4:7], s92 offen offset:3072 lds
    s_add_u32 m0, s82, 133120
    s_add_u32 s92, s80, s69
    buffer_load_dwordx4 v193, s[8:11], s92 offen lds
    s_add_u32 m0, s82, 134144
    s_nop 0
    buffer_load_dwordx4 v193, s[12:15], s92 offen lds
    s_mov_b32 s18, 1835008
    s_mov_b32 s19, 0x20000
    s_mov_b32 s38, 524288
    s_mov_b32 s39, 0x20000
    s_mov_b32 s42, 524288
    s_mov_b32 s43, 0x20000
    s_bitcmp1_b32 s62, 0
    s_cselect_b32 s16, s60, s16
    s_cselect_b32 s17, s61, s17
    s_mov_b32 s22, 1835008
    s_mov_b32 s23, 0x20000
    s_mul_i32 s67, s64, 112
    s_lshl_b32 s76, s62, 4
    s_add_u32 s67, s67, s76
    s_lshl_b32 s67, s67, 10
    s_lshl_b32 s76, s63, 6
    s_add_u32 s67, s67, s76
    v_lshrrev_b32 v238, 2, v223
    v_and_b32 v245, 3, v223
    v_lshlrev_b32 v239, 4, v245
    v_lshl_add_u32 v238, v238, 10, v239
    v_add_u32 v112, s67, v238
    v_add_u32 v113, 0x10000, v112
    s_mov_b32 s83, 0x3f803f80
    v_lshrrev_b32 v235, 5, v223
    v_bfe_u32 v236, v223, 1, 3
    v_xor_b32 v236, v236, v235
    v_lshlrev_b32 v236, 4, v236
    v_and_b32 v237, 7, v223
    v_lshlrev_b32 v237, 7, v237
    v_bfe_u32 v238, v223, 3, 2
    v_lshl_add_u32 v239, v238, 10, v237
    v_add_u32 v239, s82, v239
    v_lshl_add_u32 v240, v238, 12, v237
    v_add_u32 v240, 131072, v240
    v_xor_b32 v241, 0, v236
    v_add_u32 v172, v239, v241
    v_add_u32 v176, v240, v241
    v_xor_b32 v241, 32, v236
    v_add_u32 v173, v239, v241
    v_add_u32 v177, v240, v241
    v_xor_b32 v241, 64, v236
    v_add_u32 v174, v239, v241
    v_add_u32 v178, v240, v241
    v_xor_b32 v241, 96, v236
    v_add_u32 v175, v239, v241
    v_add_u32 v179, v240, v241
    s_lshl_b32 s67, s62, 5
    v_xor_b32 v241, s67, v236
    v_add_u32 v180, v240, v241
    v_bfe_u32 v241, v223, 2, 1
    v_bfe_u32 v246, v223, 4, 1
    v_xor_b32 v241, v241, v246
    v_or_b32 v241, v241, v245
    v_cmp_eq_u32 vcc, 0, v241
    v_mov_b32 v242, s83
    v_mov_b32 v209, 0
    v_cndmask_b32 v156, 0, v242, vcc
    v_mov_b32 v210, 0
    v_mov_b32 v157, v156
    v_mov_b32 v158, v156
    v_mov_b32 v159, v156
    v_lshlrev_b32 v194, 4, v223
    v_mov_b32 v248, 1073741824
    s_and_b32 s67, s62, 1
    s_lshl_b32 s67, s67, 1
    v_add_u32 v250, s67, v246
    v_bfe_u32 v251, v223, 1, 2
    v_xor_b32 v250, v250, v251
    v_and_b32 v251, 1, v223
    v_lshlrev_b32 v251, 4, v251
    s_movk_i32 s76, 3584
    v_mad_u32_u24 v251, v225, s76, v251
    v_add_u32 v229, s65, v250
    v_cmp_gt_u32 vcc, s65, v250
    v_lshl_add_u32 v136, v229, 5, v251
    v_add_u32 v229, 4, v250
    v_cndmask_b32 v229, v229, v250, vcc
    v_cmp_eq_u32 vcc, 3, v250
    v_lshl_add_u32 v142, v229, 5, v251
    v_add_u32 v137, 56320, v136
    v_cndmask_b32 v142, v142, v248, vcc
    v_add_u32 v138, 112640, v136
    v_add_u32 v139, 168960, v136
    s_mul_i32 s81, s64, 224
    s_lshr_b32 s67, s62, 1
    s_mul_i32 s67, s67, 28672
    s_add_u32 s81, s81, s67
    s_lshl_b32 s67, s2, 1
    s_lshr_b32 s76, s62, 1
    s_add_u32 s67, s67, s76
    s_lshl_b32 s67, s67, 10
    s_bitcmp1_b32 s62, 0
    s_cselect_b32 s76, 1073741824, s67
    s_cselect_b32 s67, s67, 1073741824
    v_add_u32 v116, s67, v194
    v_add_u32 v117, s76, v194
    s_mul_i32 s92, s68, 1792
    s_add_u32 s92, s92, s81
    buffer_load_dwordx4 a[208:211], v136, s[16:19], s92 offen offset:0
    buffer_load_dwordx4 a[212:215], v137, s[16:19], s92 offen offset:1024
    buffer_load_dwordx4 a[216:219], v138, s[16:19], s92 offen offset:2048
    buffer_load_dwordx4 a[220:223], v139, s[16:19], s92 offen offset:3072
    s_mov_b32 s26, 16777216
    s_mov_b32 s27, 0x20000
    s_mov_b32 s46, 4194304
    s_mov_b32 s47, 0x20000
    s_lshl_b32 s95, s63, 9
    s_lshr_b32 s67, s64, 2
    s_lshl_b32 s67, s67, 7
    s_add_u32 s95, s95, s67
    s_lshl_b32 s67, s65, 2
    s_add_u32 s95, s95, s67
    s_add_u32 s95, s95, 15925248
    s_waitcnt lgkmcnt(0)
    s_add_u32 s99, s99, 1
    s_cmp_eq_u32 s62, 3
    s_cselect_b32 s95, s95, 1073741824
    v_mov_b32 v254, s95
    v_cmp_eq_u32 vcc, 0, v223
    v_mov_b32 v161, 0
    v_mov_b32 v162, 0
    v_mov_b32 v163, 0
    v_mov_b32 v165, 0
    v_mov_b32 v166, 0
    v_mov_b32 v167, 0
    v_mov_b32 v169, 0
    v_mov_b32 v170, 0
    v_mov_b32 v171, 0
    v_cndmask_b32 v254, v248, v254, vcc
    s_lshl_b32 s77, s63, 2
    s_lshr_b32 s78, s64, 2
    s_add_u32 s77, s77, s78
    s_mul_i32 s77, s77, 28672
    s_add_u32 s77, s77, 12582912
    s_xor_b32 s66, s65, 0
    s_sub_u32 s78, s62, s66
    s_add_u32 s76, s62, 4
    s_sub_u32 s67, s76, s66
    s_cmp_lt_u32 s62, s66
    s_cselect_b32 s78, s76, s78
    s_cselect_b32 s67, s67, s76
    s_lshl_b32 s78, s78, 2
    s_add_u32 s78, s78, s66
    s_lshl_b32 s78, s78, 10
    s_add_u32 s78, s78, s77
    v_add_u32 v120, s78, v194
    s_lshl_b32 s67, s67, 2
    s_add_u32 s67, s67, s66
    s_lshl_b32 s67, s67, 10
    s_add_u32 s67, s67, s77
    s_cmp_eq_u32 s62, 3
    s_cselect_b32 s67, 1073741824, s67
    v_add_u32 v121, s67, v194
    s_mov_b32 s93, 1069066811
    s_mov_b32 s94, 1042479491
    s_lshl_b32 s67, s64, 13
    s_add_u32 s67, s67, 15728640
    s_add_u32 s32, s24, s67
    s_addc_u32 s33, s25, 0
    s_mov_b32 s34, 8192
    s_mov_b32 s35, 0x20000
    v_lshrrev_b32 v241, 4, v223
    v_bfe_u32 v244, v223, 2, 2
    v_lshlrev_b32 v141, 7, v244
    v_lshl_add_u32 v141, v241, 12, v141
    v_lshl_add_u32 v141, v245, 3, v141
    v_bfe_u32 v140, v223, 3, 1
    v_lshl_add_u32 v140, v246, 1, v140
    v_lshlrev_b32 v140, 5, v140
    s_add_u32 s67, s62, 0
    s_and_b32 s67, s67, 3
    s_lshl_b32 s67, s67, 5
    v_xor_b32 v181, s67, v140
    v_add_u32 v181, v141, v181
    v_add_u32 v185, 0x10000, v181
    s_add_u32 s67, s62, 1
    s_and_b32 s67, s67, 3
    s_lshl_b32 s67, s67, 5
    v_xor_b32 v182, s67, v140
    v_add_u32 v182, v141, v182
    v_add_u32 v186, 0x10000, v182
    s_add_u32 s67, s62, 2
    s_and_b32 s67, s67, 3
    s_lshl_b32 s67, s67, 5
    v_xor_b32 v183, s67, v140
    v_add_u32 v183, v141, v183
    v_add_u32 v187, 0x10000, v183
    s_add_u32 s67, s62, 3
    s_and_b32 s67, s67, 3
    s_lshl_b32 s67, s67, 5
    v_xor_b32 v184, s67, v140
    v_add_u32 v184, v141, v184
    v_add_u32 v188, 0x10000, v184
    s_mul_i32 s67, s62, 5120
    s_add_u32 s67, s67, 139264
    v_mul_u32_u24 v216, 80, v222
    v_lshl_add_u32 v216, v235, 5, v216
    v_add_u32 v216, s67, v216
    v_lshl_add_u32 v217, v235, 3, v244
    v_mul_u32_u24 v217, 80, v217
    v_and_b32 v247, 1, v223
    v_lshl_add_u32 v217, v247, 5, v217
    v_lshl_add_u32 v217, v246, 4, v217
    v_bfe_u32 v247, v223, 1, 1
    v_lshl_add_u32 v217, v247, 3, v217
    v_add_u32 v217, s67, v217
    v_lshl_add_u32 v143, v235, 2, v244
    v_lshlrev_b32 v143, 6, v143
    v_lshl_add_u32 v143, v246, 5, v143
    v_lshl_add_u32 v143, v245, 3, v143
    v_add_u32 v143, s67, v143
    v_add_u32 v124, s67, v194
    s_lshl_b32 s67, s62, 1
    v_add_u32 v247, s67, v235
    v_lshlrev_b32 v214, 8, v247
    v_lshl_add_u32 v214, v222, 3, v214
    v_add_u32 v214, 131072, v214
    v_add_u32 v213, 1792, v214
    s_sub_u32 s67, 15, s63
    s_lshl_b32 s67, s67, 9
    v_lshlrev_b32 v211, 4, v222
    v_add_u32 v211, s67, v211
    v_cmp_eq_u32 vcc, 7, v247
    v_lshlrev_b32 v249, 9, v235
    v_sub_u32 v212, v211, v249
    s_lshl_b32 s67, s62, 11
    s_sub_u32 s67, 7168, s67
    v_add_u32 v212, s67, v212
    v_cndmask_b32 v211, v248, v211, vcc
    v_bfe_u32 v249, v223, 2, 1
    v_lshlrev_b32 v249, 4, v249
    v_lshl_add_u32 v249, v238, 2, v249
    v_add_u32 v249, v249, v245
    s_lshr_b32 s67, s79, 7
    s_lshl_b32 s76, s64, 12
    s_add_u32 s67, s67, s76
    s_add_u32 s67, s67, 15859712
    s_cmp_eq_u32 s65, 0
    s_cselect_b32 s67, s67, 1073741824
    v_lshrrev_b32 v221, 2, v237
    v_lshl_add_u32 v221, v238, 3, v221
    v_add_u32 v221, s67, v221
    s_lshl_b32 s67, s62, 7
    s_add_u32 s67, s67, 138240
    v_lshlrev_b32 v207, 2, v249
    v_add_u32 v207, s67, v207
    v_lshlrev_b32 v215, 6, v235
    v_add_u32 v215, s67, v215
    s_lshl_b32 s67, s62, 2
    v_lshlrev_b32 v219, 4, v222
    v_add_u32 v219, 135168, v219
    v_add_u32 v218, s67, v219
    v_lshlrev_b32 v220, 2, v222
    v_add_u32 v220, 136192, v220
    s_waitcnt vmcnt(12)
    v_lshlrev_b32 v232, 16, v232
    s_waitcnt vmcnt(11)
    v_lshlrev_b32 v233, 16, v233
    s_waitcnt vmcnt(10)
    v_lshlrev_b32 v234, 16, v234
    v_mul_f32 v234, s93, v234
    v_exp_f32 v234, v234
    v_cvt_f32_u32 v227, v247
    v_cvt_pk_bf16_f32 v234, v234, v234
    v_and_b32 v234, 0xffff0000, v234
    v_mul_f32 v250, v234, v232
    v_mul_f32 v251, v234, v233
    v_mul_f32 v250, s93, v250
    v_mul_f32 v251, s94, v251
    v_mul_f32 v227, 0x41800000, v227
    v_exp_f32 v225, v250
    v_fract_f32 v226, v251
    v_cos_f32 v197, v226
    v_sin_f32 v198, v226
    v_mul_f32 v197, v225, v197
    v_mul_f32 v198, v225, v198
    v_mul_f32 v225, 0x41800000, v250
    v_mul_f32 v226, 0x41800000, v251
    v_exp_f32 v225, v225
    v_fract_f32 v226, v226
    v_cos_f32 v199, v226
    v_sin_f32 v200, v226
    v_mul_f32 v199, v225, v199
    v_mul_f32 v200, v225, v200
    v_mul_f32 v225, 0x43000000, v250
    v_mul_f32 v226, 0x43000000, v251
    v_exp_f32 v225, v225
    v_fract_f32 v226, v226
    v_cos_f32 v201, v226
    v_sin_f32 v202, v226
    v_mul_f32 v201, v225, v201
    v_mul_f32 v202, v225, v202
    v_mul_f32 v225, 0x43800000, v250
    v_mul_f32 v226, 0x43800000, v251
    v_exp_f32 v225, v225
    v_fract_f32 v226, v226
    v_cos_f32 v252, v226
    v_sin_f32 v253, v226
    v_mul_f32 v252, v225, v252
    v_mul_f32 v253, v225, v253
    v_mul_f32 v225, v227, v250
    v_mul_f32 v226, v227, v251
    v_exp_f32 v225, v225
    v_fract_f32 v226, v226
    v_cos_f32 v203, v226
    v_sin_f32 v204, v226
Lmark0:
    s_barrier
    ds_read_b128 v[48:51], v172 offset:0
    ds_read_b128 v[52:55], v173 offset:0
    ds_read_b128 v[56:59], v174 offset:0
    ds_read_b128 v[60:63], v175 offset:0
    ds_read_b128 a[128:131], v176 offset:0
    ds_read_b128 a[132:135], v176 offset:1024
    ds_read_b128 a[136:139], v177 offset:0
    ds_read_b128 a[140:143], v177 offset:1024
    ds_read_b128 a[144:147], v178 offset:0
    ds_read_b128 a[148:151], v178 offset:1024
    ds_read_b128 a[152:155], v179 offset:0
    ds_read_b128 a[156:159], v179 offset:1024
    ds_read_b128 a[160:163], v180 offset:0
    ds_read_b128 a[164:167], v180 offset:1024
    s_add_u32 m0, s82, 32768
    s_add_u32 s92, s79, s70
    buffer_load_dwordx4 v189, s[4:7], s92 offen offset:0 lds
    buffer_load_dwordx4 v190, s[4:7], s92 offen offset:1024 lds
    buffer_load_dwordx4 v191, s[4:7], s92 offen offset:2048 lds
    buffer_load_dwordx4 v192, s[4:7], s92 offen offset:3072 lds
    s_add_u32 m0, s82, 147456
    s_add_u32 s92, s80, s70
    buffer_load_dwordx4 v193, s[8:11], s92 offen lds
    s_add_u32 m0, s82, 148480
    s_nop 0
    buffer_load_dwordx4 v193, s[12:15], s92 offen lds
    s_waitcnt lgkmcnt(0)
    v_dot2_f32_bf16 v209, v48, s83, v209
    v_dot2_f32_bf16 v210, v48, v48, v210
    v_dot2_f32_bf16 v209, v49, s83, v209
    v_dot2_f32_bf16 v210, v49, v49, v210
    s_add_u32 m0, s82, 49152
    s_add_u32 s92, s79, s71
    buffer_load_dwordx4 v189, s[4:7], s92 offen offset:0 lds
    v_dot2_f32_bf16 v209, v50, s83, v209
    v_dot2_f32_bf16 v210, v50, v50, v210
    v_dot2_f32_bf16 v209, v51, s83, v209
    v_dot2_f32_bf16 v210, v51, v51, v210
    v_dot2_f32_bf16 v209, v52, s83, v209
    v_dot2_f32_bf16 v210, v52, v52, v210
    v_dot2_f32_bf16 v209, v53, s83, v209
    v_dot2_f32_bf16 v210, v53, v53, v210
    v_dot2_f32_bf16 v209, v54, s83, v209
    v_dot2_f32_bf16 v210, v54, v54, v210
    v_dot2_f32_bf16 v209, v55, s83, v209
    v_dot2_f32_bf16 v210, v55, v55, v210
    v_dot2_f32_bf16 v209, v56, s83, v209
    v_dot2_f32_bf16 v210, v56, v56, v210
    v_dot2_f32_bf16 v209, v57, s83, v209
    v_dot2_f32_bf16 v210, v57, v57, v210
    buffer_load_dwordx4 v190, s[4:7], s92 offen offset:1024 lds
    v_dot2_f32_bf16 v209, v58, s83, v209
    v_dot2_f32_bf16 v210, v58, v58, v210
    v_dot2_f32_bf16 v209, v59, s83, v209
    v_dot2_f32_bf16 v210, v59, v59, v210
    v_dot2_f32_bf16 v209, v60, s83, v209
    v_dot2_f32_bf16 v210, v60, v60, v210
    v_dot2_f32_bf16 v209, v61, s83, v209
    v_dot2_f32_bf16 v210, v61, v61, v210
    v_dot2_f32_bf16 v209, v62, s83, v209
    v_dot2_f32_bf16 v210, v62, v62, v210
    v_dot2_f32_bf16 v209, v63, s83, v209
    v_dot2_f32_bf16 v210, v63, v63, v210
    s_waitcnt vmcnt(12)
    s_barrier
    v_mfma_f32_32x32x16_bf16 v[0:15], v[48:51], a[128:131], 0
    ds_read_b128 v[32:35], v172 offset:16384
    ds_read_b128 v[36:39], v173 offset:16384
    v_accvgpr_write_b32 a0, v48
    v_accvgpr_write_b32 a1, v49
    v_mul_f32 v203, v225, v203
    v_mul_f32 v204, v225, v204
    v_mfma_f32_32x32x16_bf16 v[16:31], v[48:51], a[132:135], 0
    ds_read_b128 v[40:43], v174 offset:16384
    ds_read_b128 v[44:47], v175 offset:16384
    v_accvgpr_write_b32 a2, v50
    v_accvgpr_write_b32 a3, v51
    v_mul_f32 v226, v232, v232
    v_fma_f32 v226, v233, v233, v226
    v_mfma_f32_32x32x16_bf16 v[0:15], v[52:55], a[136:139], v[0:15]
    ds_read_b128 a[168:171], v176 offset:2048
    ds_read_b128 a[172:175], v176 offset:3072
    v_accvgpr_write_b32 a4, v52
    v_accvgpr_write_b32 a5, v53
    buffer_load_dwordx4 v191, s[4:7], s92 offen offset:2048 lds
    v_rcp_f32 v226, v226
    v_mfma_f32_32x32x16_bf16 v[16:31], v[52:55], a[140:143], v[16:31]
    ds_read_b128 a[176:179], v177 offset:2048
    ds_read_b128 a[180:183], v177 offset:3072
    v_accvgpr_write_b32 a6, v54
    v_accvgpr_write_b32 a7, v55
    buffer_load_dwordx4 v192, s[4:7], s92 offen offset:3072 lds
    v_add_f32 v225, -1.0, v197
    v_mfma_f32_32x32x16_bf16 v[0:15], v[56:59], a[144:147], v[0:15]
    ds_read_b128 a[184:187], v178 offset:2048
    ds_read_b128 a[188:191], v178 offset:3072
    v_accvgpr_write_b32 a8, v56
    v_accvgpr_write_b32 a9, v57
    s_add_u32 m0, s82, 149504
    s_add_u32 s92, s80, s71
    buffer_load_dwordx4 v193, s[8:11], s92 offen lds
    v_mfma_f32_32x32x16_bf16 v[16:31], v[56:59], a[148:151], v[16:31]
    ds_read_b128 a[192:195], v179 offset:2048
    ds_read_b128 a[196:199], v179 offset:3072
    v_accvgpr_write_b32 a10, v58
    v_accvgpr_write_b32 a11, v59
    s_add_u32 m0, s82, 150528
    s_nop 0
    buffer_load_dwordx4 v193, s[12:15], s92 offen lds
    v_mfma_f32_32x32x16_bf16 v[0:15], v[60:63], a[152:155], v[0:15]
    ds_read_b128 a[200:203], v180 offset:2048
    ds_read_b128 a[204:207], v180 offset:3072
    v_accvgpr_write_b32 a12, v60
    v_accvgpr_write_b32 a13, v61
    v_mul_f32 v205, v225, v232
    v_fma_f32 v205, v198, v233, v205
    v_mfma_f32_32x32x16_bf16 v[16:31], v[60:63], a[156:159], v[16:31]
    v_accvgpr_write_b32 a14, v62
    v_accvgpr_write_b32 a15, v63
    v_mul_f32 v206, v198, v232
    v_fma_f32 v206, -v225, v233, v206
    v_mfma_f32_16x16x32_bf16 v[144:147], v[156:159], a[160:163], 0
    v_mfma_f32_16x16x32_bf16 v[148:151], v[156:159], a[164:167], 0
    s_waitcnt lgkmcnt(0)
    v_dot2_f32_bf16 v209, v32, s83, v209
    v_dot2_f32_bf16 v210, v32, v32, v210
    v_dot2_f32_bf16 v209, v33, s83, v209
    v_dot2_f32_bf16 v210, v33, v33, v210
    s_add_u32 m0, s82, 65536
    s_add_u32 s92, s79, s72
    buffer_load_dwordx4 v189, s[4:7], s92 offen offset:0 lds
    v_dot2_f32_bf16 v209, v34, s83, v209
    v_dot2_f32_bf16 v210, v34, v34, v210
    v_dot2_f32_bf16 v209, v35, s83, v209
    v_dot2_f32_bf16 v210, v35, v35, v210
    v_dot2_f32_bf16 v209, v36, s83, v209
    v_dot2_f32_bf16 v210, v36, v36, v210
    v_dot2_f32_bf16 v209, v37, s83, v209
    v_dot2_f32_bf16 v210, v37, v37, v210
    v_dot2_f32_bf16 v209, v38, s83, v209
    v_dot2_f32_bf16 v210, v38, v38, v210
    v_dot2_f32_bf16 v209, v39, s83, v209
    v_dot2_f32_bf16 v210, v39, v39, v210
    v_dot2_f32_bf16 v209, v40, s83, v209
    v_dot2_f32_bf16 v210, v40, v40, v210
    v_dot2_f32_bf16 v209, v41, s83, v209
    v_dot2_f32_bf16 v210, v41, v41, v210
    buffer_load_dwordx4 v190, s[4:7], s92 offen offset:1024 lds
    v_dot2_f32_bf16 v209, v42, s83, v209
    v_dot2_f32_bf16 v210, v42, v42, v210
    v_dot2_f32_bf16 v209, v43, s83, v209
    v_dot2_f32_bf16 v210, v43, v43, v210
    v_dot2_f32_bf16 v209, v44, s83, v209
    v_dot2_f32_bf16 v210, v44, v44, v210
    v_dot2_f32_bf16 v209, v45, s83, v209
    v_dot2_f32_bf16 v210, v45, v45, v210
    v_dot2_f32_bf16 v209, v46, s83, v209
    v_dot2_f32_bf16 v210, v46, v46, v210
    v_dot2_f32_bf16 v209, v47, s83, v209
    v_dot2_f32_bf16 v210, v47, v47, v210
    s_waitcnt vmcnt(8)
    s_barrier
    v_mfma_f32_32x32x16_bf16 v[0:15], v[32:35], a[168:171], v[0:15]
    ds_read_b128 v[48:51], v172 offset:32768
    ds_read_b128 v[52:55], v173 offset:32768
    v_accvgpr_write_b32 a16, v32
    v_accvgpr_write_b32 a17, v33
    v_add_f32 v226, v226, v226
    v_mul_f32 v205, v205, v226
    v_mfma_f32_32x32x16_bf16 v[16:31], v[32:35], a[172:175], v[16:31]
    ds_read_b128 v[56:59], v174 offset:32768
    ds_read_b128 v[60:63], v175 offset:32768
    v_accvgpr_write_b32 a18, v34
    v_accvgpr_write_b32 a19, v35
    v_mul_f32 v206, v206, v226
    v_mov_b32 v247, s99
    v_mfma_f32_32x32x16_bf16 v[0:15], v[36:39], a[176:179], v[0:15]
    ds_read_b128 a[128:131], v176 offset:16384
    ds_read_b128 a[132:135], v176 offset:17408
    v_accvgpr_write_b32 a20, v36
    v_accvgpr_write_b32 a21, v37
    buffer_load_dwordx4 v191, s[4:7], s92 offen offset:2048 lds
    s_and_b32 s67, s2, 7
    v_mfma_f32_32x32x16_bf16 v[16:31], v[36:39], a[180:183], v[16:31]
    ds_read_b128 a[136:139], v177 offset:16384
    ds_read_b128 a[140:143], v177 offset:17408
    v_accvgpr_write_b32 a22, v38
    v_accvgpr_write_b32 a23, v39
    buffer_load_dwordx4 v192, s[4:7], s92 offen offset:3072 lds
    s_lshr_b32 s76, s2, 3
    v_mfma_f32_32x32x16_bf16 v[0:15], v[40:43], a[184:187], v[0:15]
    ds_read_b128 a[144:147], v178 offset:16384
    ds_read_b128 a[148:151], v178 offset:17408
    v_accvgpr_write_b32 a24, v40
    v_accvgpr_write_b32 a25, v41
    s_add_u32 m0, s82, 0
    s_add_u32 s92, s80, s72
    buffer_load_dwordx4 v193, s[8:11], s92 offen lds
    v_mfma_f32_32x32x16_bf16 v[16:31], v[40:43], a[188:191], v[16:31]
    ds_read_b128 a[152:155], v179 offset:16384
    ds_read_b128 a[156:159], v179 offset:17408
    v_accvgpr_write_b32 a26, v42
    v_accvgpr_write_b32 a27, v43
    s_add_u32 m0, s82, 1024
    s_nop 0
    buffer_load_dwordx4 v193, s[12:15], s92 offen lds
    v_mfma_f32_32x32x16_bf16 v[0:15], v[44:47], a[192:195], v[0:15]
    ds_read_b128 a[160:163], v180 offset:16384
    ds_read_b128 a[164:167], v180 offset:17408
    v_accvgpr_write_b32 a28, v44
    v_accvgpr_write_b32 a29, v45
    s_lshl_b32 s50, s67, 2
    s_and_b32 s67, s76, 3
    v_mfma_f32_32x32x16_bf16 v[16:31], v[44:47], a[196:199], v[16:31]
    v_accvgpr_write_b32 a30, v46
    v_accvgpr_write_b32 a31, v47
    s_add_u32 s50, s50, s67
    s_lshr_b32 s51, s76, 2
    v_mfma_f32_16x16x32_bf16 v[144:147], v[156:159], a[200:203], v[144:147]
    v_mfma_f32_16x16x32_bf16 v[148:151], v[156:159], a[204:207], v[148:151]
    s_waitcnt lgkmcnt(0)
    v_dot2_f32_bf16 v209, v48, s83, v209
    v_dot2_f32_bf16 v210, v48, v48, v210
    v_dot2_f32_bf16 v209, v49, s83, v209
    v_dot2_f32_bf16 v210, v49, v49, v210
    s_add_u32 m0, s82, 81920
    s_add_u32 s92, s79, s73
    buffer_load_dwordx4 v189, s[4:7], s92 offen offset:0 lds
    v_dot2_f32_bf16 v209, v50, s83, v209
    v_dot2_f32_bf16 v210, v50, v50, v210
    v_dot2_f32_bf16 v209, v51, s83, v209
    v_dot2_f32_bf16 v210, v51, v51, v210
    v_dot2_f32_bf16 v209, v52, s83, v209
    v_dot2_f32_bf16 v210, v52, v52, v210
    v_dot2_f32_bf16 v209, v53, s83, v209
    v_dot2_f32_bf16 v210, v53, v53, v210
    v_dot2_f32_bf16 v209, v54, s83, v209
    v_dot2_f32_bf16 v210, v54, v54, v210
    v_dot2_f32_bf16 v209, v55, s83, v209
    v_dot2_f32_bf16 v210, v55, v55, v210
    v_dot2_f32_bf16 v209, v56, s83, v209
    v_dot2_f32_bf16 v210, v56, v56, v210
    v_dot2_f32_bf16 v209, v57, s83, v209
    v_dot2_f32_bf16 v210, v57, v57, v210
    buffer_load_dwordx4 v190, s[4:7], s92 offen offset:1024 lds
    v_dot2_f32_bf16 v209, v58, s83, v209
    v_dot2_f32_bf16 v210, v58, v58, v210
    v_dot2_f32_bf16 v209, v59, s83, v209
    v_dot2_f32_bf16 v210, v59, v59, v210
    v_dot2_f32_bf16 v209, v60, s83, v209
    v_dot2_f32_bf16 v210, v60, v60, v210
    v_dot2_f32_bf16 v209, v61, s83, v209
    v_dot2_f32_bf16 v210, v61, v61, v210
    v_dot2_f32_bf16 v209, v62, s83, v209
    v_dot2_f32_bf16 v210, v62, v62, v210
    v_dot2_f32_bf16 v209, v63, s83, v209
    v_dot2_f32_bf16 v210, v63, v63, v210
    s_waitcnt vmcnt(8)
    s_barrier
    v_mfma_f32_32x32x16_bf16 v[0:15], v[48:51], a[128:131], v[0:15]
    ds_read_b128 v[32:35], v172 offset:49152
    ds_read_b128 v[36:39], v173 offset:49152
    v_accvgpr_write_b32 a32, v48
    v_accvgpr_write_b32 a33, v49
    s_lshl_b32 s50, s50, 1
    s_lshr_b32 s67, s62, 1
    v_mfma_f32_32x32x16_bf16 v[16:31], v[48:51], a[132:135], v[16:31]
    ds_read_b128 v[40:43], v174 offset:49152
    ds_read_b128 v[44:47], v175 offset:49152
    v_accvgpr_write_b32 a34, v50
    v_accvgpr_write_b32 a35, v51
    s_add_u32 s50, s50, s67
    s_lshl_b32 s51, s51, 1
    v_mfma_f32_32x32x16_bf16 v[0:15], v[52:55], a[136:139], v[0:15]
    ds_read_b128 a[168:171], v176 offset:18432
    ds_read_b128 a[172:175], v176 offset:19456
    v_accvgpr_write_b32 a36, v52
    v_accvgpr_write_b32 a37, v53
    buffer_load_dwordx4 v191, s[4:7], s92 offen offset:2048 lds
    s_and_b32 s67, s62, 1
    v_mfma_f32_32x32x16_bf16 v[16:31], v[52:55], a[140:143], v[16:31]
    ds_read_b128 a[176:179], v177 offset:18432
    ds_read_b128 a[180:183], v177 offset:19456
    v_accvgpr_write_b32 a38, v54
    v_accvgpr_write_b32 a39, v55
    buffer_load_dwordx4 v192, s[4:7], s92 offen offset:3072 lds
    s_add_u32 s51, s51, s67
    v_mfma_f32_32x32x16_bf16 v[0:15], v[56:59], a[144:147], v[0:15]
    ds_read_b128 a[184:187], v178 offset:18432
    ds_read_b128 a[188:191], v178 offset:19456
    v_accvgpr_write_b32 a40, v56
    v_accvgpr_write_b32 a41, v57
    s_add_u32 m0, s82, 2048
    s_add_u32 s92, s80, s73
    buffer_load_dwordx4 v193, s[8:11], s92 offen lds
    v_mfma_f32_32x32x16_bf16 v[16:31], v[56:59], a[148:151], v[16:31]
    ds_read_b128 a[192:195], v179 offset:18432
    ds_read_b128 a[196:199], v179 offset:19456
    v_accvgpr_write_b32 a42, v58
    v_accvgpr_write_b32 a43, v59
    s_add_u32 m0, s82, 3072
    s_nop 0
    buffer_load_dwordx4 v193, s[12:15], s92 offen lds
    v_mfma_f32_32x32x16_bf16 v[0:15], v[60:63], a[152:155], v[0:15]
    ds_read_b128 a[200:203], v180 offset:18432
    ds_read_b128 a[204:207], v180 offset:19456
    v_accvgpr_write_b32 a44, v60
    v_accvgpr_write_b32 a45, v61
    s_mul_i32 s77, s62, 44
    s_lshl_b32 s78, s62, 8
    v_mfma_f32_32x32x16_bf16 v[16:31], v[60:63], a[156:159], v[16:31]
    v_accvgpr_write_b32 a46, v62
    v_accvgpr_write_b32 a47, v63
    s_lshr_b32 s67, s51, 1
    s_lshr_b32 s76, s50, 1
    v_mfma_f32_16x16x32_bf16 v[144:147], v[156:159], a[160:163], v[144:147]
    v_mfma_f32_16x16x32_bf16 v[148:151], v[156:159], a[164:167], v[148:151]
    s_waitcnt lgkmcnt(0)
    v_dot2_f32_bf16 v209, v32, s83, v209
    v_dot2_f32_bf16 v210, v32, v32, v210
    v_dot2_f32_bf16 v209, v33, s83, v209
    v_dot2_f32_bf16 v210, v33, v33, v210
    s_add_u32 m0, s82, 98304
    s_add_u32 s92, s79, s74
    buffer_load_dwordx4 v189, s[4:7], s92 offen offset:0 lds
    v_dot2_f32_bf16 v209, v34, s83, v209
    v_dot2_f32_bf16 v210, v34, v34, v210
    v_dot2_f32_bf16 v209, v35, s83, v209
    v_dot2_f32_bf16 v210, v35, v35, v210
    v_dot2_f32_bf16 v209, v36, s83, v209
    v_dot2_f32_bf16 v210, v36, v36, v210
    v_dot2_f32_bf16 v209, v37, s83, v209
    v_dot2_f32_bf16 v210, v37, v37, v210
    v_dot2_f32_bf16 v209, v38, s83, v209
    v_dot2_f32_bf16 v210, v38, v38, v210
    v_dot2_f32_bf16 v209, v39, s83, v209
    v_dot2_f32_bf16 v210, v39, v39, v210
    v_dot2_f32_bf16 v209, v40, s83, v209
    v_dot2_f32_bf16 v210, v40, v40, v210
    v_dot2_f32_bf16 v209, v41, s83, v209
    v_dot2_f32_bf16 v210, v41, v41, v210
    buffer_load_dwordx4 v190, s[4:7], s92 offen offset:1024 lds
    v_dot2_f32_bf16 v209, v42, s83, v209
    v_dot2_f32_bf16 v210, v42, v42, v210
    v_dot2_f32_bf16 v209, v43, s83, v209
    v_dot2_f32_bf16 v210, v43, v43, v210
    v_dot2_f32_bf16 v209, v44, s83, v209
    v_dot2_f32_bf16 v210, v44, v44, v210
    v_dot2_f32_bf16 v209, v45, s83, v209
    v_dot2_f32_bf16 v210, v45, v45, v210
    v_dot2_f32_bf16 v209, v46, s83, v209
    v_dot2_f32_bf16 v210, v46, v46, v210
    v_dot2_f32_bf16 v209, v47, s83, v209
    v_dot2_f32_bf16 v210, v47, v47, v210
    v_add_u32 v172, 0x10000, v172
    v_add_u32 v176, 4294836224, v176
    v_add_u32 v173, 0x10000, v173
    v_add_u32 v177, 4294836224, v177
    v_add_u32 v174, 0x10000, v174
    v_add_u32 v178, 4294836224, v178
    v_add_u32 v175, 0x10000, v175
    v_add_u32 v179, 4294836224, v179
    v_add_u32 v180, 4294836224, v180
    s_waitcnt vmcnt(8)
    s_barrier
    v_mfma_f32_32x32x16_bf16 v[0:15], v[32:35], a[168:171], v[0:15]
    ds_read_b128 v[48:51], v172 offset:0
    ds_read_b128 v[52:55], v173 offset:0
    v_accvgpr_write_b32 a48, v32
    v_accvgpr_write_b32 a49, v33
    s_and_b32 s58, s67, 4
    s_add_u32 s76, s76, s67
    v_mfma_f32_32x32x16_bf16 v[16:31], v[32:35], a[172:175], v[16:31]
    ds_read_b128 v[56:59], v174 offset:0
    ds_read_b128 v[60:63], v175 offset:0
    v_accvgpr_write_b32 a50, v34
    v_accvgpr_write_b32 a51, v35
    s_and_b32 s59, s76, 3
    s_lshl_b32 s58, s58, 10
    v_mfma_f32_32x32x16_bf16 v[0:15], v[36:39], a[176:179], v[0:15]
    ds_read_b128 a[128:131], v176 offset:0
    ds_read_b128 a[132:135], v176 offset:1024
    v_accvgpr_write_b32 a52, v36
    v_accvgpr_write_b32 a53, v37
    buffer_load_dwordx4 v191, s[4:7], s92 offen offset:2048 lds
    s_xor_b32 s76, s58, 4096
    v_mfma_f32_32x32x16_bf16 v[16:31], v[36:39], a[180:183], v[16:31]
    ds_read_b128 a[136:139], v177 offset:0
    ds_read_b128 a[140:143], v177 offset:1024
    v_accvgpr_write_b32 a54, v38
    v_accvgpr_write_b32 a55, v39
    buffer_load_dwordx4 v192, s[4:7], s92 offen offset:3072 lds
    s_xor_b32 s67, s50, 0
    v_mfma_f32_32x32x16_bf16 v[0:15], v[40:43], a[184:187], v[0:15]
    ds_read_b128 a[144:147], v178 offset:0
    ds_read_b128 a[148:151], v178 offset:1024
    v_accvgpr_write_b32 a56, v40
    v_accvgpr_write_b32 a57, v41
    s_add_u32 m0, s82, 16384
    s_add_u32 s92, s80, s74
    buffer_load_dwordx4 v193, s[8:11], s92 offen lds
    v_mfma_f32_32x32x16_bf16 v[16:31], v[40:43], a[188:191], v[16:31]
    ds_read_b128 a[152:155], v179 offset:0
    ds_read_b128 a[156:159], v179 offset:1024
    v_accvgpr_write_b32 a58, v42
    v_accvgpr_write_b32 a59, v43
    s_add_u32 m0, s82, 17408
    s_nop 0
    buffer_load_dwordx4 v193, s[12:15], s92 offen lds
    v_mfma_f32_32x32x16_bf16 v[0:15], v[44:47], a[192:195], v[0:15]
    ds_read_b128 a[160:163], v180 offset:0
    ds_read_b128 a[164:167], v180 offset:1024
    v_accvgpr_write_b32 a60, v44
    v_accvgpr_write_b32 a61, v45
    s_mul_i32 s67, s67, 176
    s_add_u32 s67, s67, s77
    v_mfma_f32_32x32x16_bf16 v[16:31], v[44:47], a[196:199], v[16:31]
    v_accvgpr_write_b32 a62, v46
    v_accvgpr_write_b32 a63, v47
    s_lshl_b32 s67, s67, 10
    s_add_u32 s54, s67, s58
    v_mfma_f32_16x16x32_bf16 v[144:147], v[156:159], a[200:203], v[144:147]
    v_mfma_f32_16x16x32_bf16 v[148:151], v[156:159], a[204:207], v[148:151]
    s_waitcnt lgkmcnt(0)
    v_dot2_f32_bf16 v209, v48, s83, v209
    v_dot2_f32_bf16 v210, v48, v48, v210
    v_dot2_f32_bf16 v209, v49, s83, v209
    v_dot2_f32_bf16 v210, v49, v49, v210
    s_add_u32 m0, s82, 114688
    s_add_u32 s92, s79, s75
    buffer_load_dwordx4 v189, s[4:7], s92 offen offset:0 lds
    v_dot2_f32_bf16 v209, v50, s83, v209
    v_dot2_f32_bf16 v210, v50, v50, v210
    v_dot2_f32_bf16 v209, v51, s83, v209
    v_dot2_f32_bf16 v210, v51, v51, v210
    v_dot2_f32_bf16 v209, v52, s83, v209
    v_dot2_f32_bf16 v210, v52, v52, v210
    v_dot2_f32_bf16 v209, v53, s83, v209
    v_dot2_f32_bf16 v210, v53, v53, v210
    v_dot2_f32_bf16 v209, v54, s83, v209
    v_dot2_f32_bf16 v210, v54, v54, v210
    v_dot2_f32_bf16 v209, v55, s83, v209
    v_dot2_f32_bf16 v210, v55, v55, v210
    v_dot2_f32_bf16 v209, v56, s83, v209
    v_dot2_f32_bf16 v210, v56, v56, v210
    v_dot2_f32_bf16 v209, v57, s83, v209
    v_dot2_f32_bf16 v210, v57, v57, v210
    buffer_load_dwordx4 v190, s[4:7], s92 offen offset:1024 lds
    v_dot2_f32_bf16 v209, v58, s83, v209
    v_dot2_f32_bf16 v210, v58, v58, v210
    v_dot2_f32_bf16 v209, v59, s83, v209
    v_dot2_f32_bf16 v210, v59, v59, v210
    v_dot2_f32_bf16 v209, v60, s83, v209
    v_dot2_f32_bf16 v210, v60, v60, v210
    v_dot2_f32_bf16 v209, v61, s83, v209
    v_dot2_f32_bf16 v210, v61, v61, v210
    v_dot2_f32_bf16 v209, v62, s83, v209
    v_dot2_f32_bf16 v210, v62, v62, v210
    v_dot2_f32_bf16 v209, v63, s83, v209
    v_dot2_f32_bf16 v210, v63, v63, v210
    s_waitcnt vmcnt(8)
    s_barrier
    v_mfma_f32_32x32x16_bf16 v[0:15], v[48:51], a[128:131], v[0:15]
    ds_read_b128 v[32:35], v172 offset:16384
    ds_read_b128 v[36:39], v173 offset:16384
    v_accvgpr_write_b32 a64, v48
    v_accvgpr_write_b32 a65, v49
    s_add_u32 s30, s67, s76
    s_xor_b32 s67, s51, 0
    v_mfma_f32_32x32x16_bf16 v[16:31], v[48:51], a[132:135], v[16:31]
    ds_read_b128 v[40:43], v174 offset:16384
    ds_read_b128 v[44:47], v175 offset:16384
    v_accvgpr_write_b32 a66, v50
    v_accvgpr_write_b32 a67, v51
    s_lshl_b32 s56, s67, 15
    s_add_u32 s56, s56, s78
    v_mfma_f32_32x32x16_bf16 v[0:15], v[52:55], a[136:139], v[0:15]
    ds_read_b128 a[168:171], v176 offset:2048
    ds_read_b128 a[172:175], v176 offset:3072
    v_accvgpr_write_b32 a68, v52
    v_accvgpr_write_b32 a69, v53
    buffer_load_dwordx4 v191, s[4:7], s92 offen offset:2048 lds
    s_lshl_b32 s67, s67, 2
    v_mfma_f32_32x32x16_bf16 v[16:31], v[52:55], a[140:143], v[16:31]
    ds_read_b128 a[176:179], v177 offset:2048
    ds_read_b128 a[180:183], v177 offset:3072
    v_accvgpr_write_b32 a70, v54
    v_accvgpr_write_b32 a71, v55
    buffer_load_dwordx4 v192, s[4:7], s92 offen offset:3072 lds
    s_add_u32 s67, s67, s62
    v_mfma_f32_32x32x16_bf16 v[0:15], v[56:59], a[144:147], v[0:15]
    ds_read_b128 a[184:187], v178 offset:2048
    ds_read_b128 a[188:191], v178 offset:3072
    v_accvgpr_write_b32 a72, v56
    v_accvgpr_write_b32 a73, v57
    s_add_u32 m0, s82, 18432
    s_add_u32 s92, s80, s75
    buffer_load_dwordx4 v193, s[8:11], s92 offen lds
    v_mfma_f32_32x32x16_bf16 v[16:31], v[56:59], a[148:151], v[16:31]
    ds_read_b128 a[192:195], v179 offset:2048
    ds_read_b128 a[196:199], v179 offset:3072
    v_accvgpr_write_b32 a74, v58
    v_accvgpr_write_b32 a75, v59
    s_add_u32 m0, s82, 19456
    s_nop 0
    buffer_load_dwordx4 v193, s[12:15], s92 offen lds
    v_mfma_f32_32x32x16_bf16 v[0:15], v[60:63], a[152:155], v[0:15]
    ds_read_b128 a[200:203], v180 offset:2048
    ds_read_b128 a[204:207], v180 offset:3072
    v_accvgpr_write_b32 a76, v60
    v_accvgpr_write_b32 a77, v61
    buffer_load_dwordx4 v[96:99], v112, s[20:23], 0 offen
    s_mul_i32 s67, s67, 28672
    v_mfma_f32_32x32x16_bf16 v[16:31], v[60:63], a[156:159], v[16:31]
    v_accvgpr_write_b32 a78, v62
    v_accvgpr_write_b32 a79, v63
    buffer_load_dwordx4 v[100:103], v113, s[20:23], 0 offen
    s_add_u32 s67, s67, 12582912
    v_mfma_f32_16x16x32_bf16 v[144:147], v[156:159], a[160:163], v[144:147]
    v_mfma_f32_16x16x32_bf16 v[148:151], v[156:159], a[164:167], v[148:151]
    buffer_load_dwordx4 a[240:243], v116, s[36:39], 0 offen
    buffer_load_dwordx4 a[244:247], v117, s[40:43], 0 offen
    s_waitcnt lgkmcnt(0)
    v_dot2_f32_bf16 v209, v32, s83, v209
    v_dot2_f32_bf16 v210, v32, v32, v210
    v_dot2_f32_bf16 v209, v33, s83, v209
    v_dot2_f32_bf16 v210, v33, v33, v210
    s_add_u32 m0, s82, 49152
    s_mul_i32 s92, s69, 1792
    s_add_u32 s92, s92, s81
    buffer_load_dwordx4 v136, s[16:19], s92 offen offset:0 lds
    v_dot2_f32_bf16 v209, v34, s83, v209
    v_dot2_f32_bf16 v210, v34, v34, v210
    v_dot2_f32_bf16 v209, v35, s83, v209
    v_dot2_f32_bf16 v210, v35, v35, v210
    v_dot2_f32_bf16 v209, v36, s83, v209
    v_dot2_f32_bf16 v210, v36, v36, v210
    v_dot2_f32_bf16 v209, v37, s83, v209
    v_dot2_f32_bf16 v210, v37, v37, v210
    v_dot2_f32_bf16 v209, v38, s83, v209
    v_dot2_f32_bf16 v210, v38, v38, v210
    v_dot2_f32_bf16 v209, v39, s83, v209
    v_dot2_f32_bf16 v210, v39, v39, v210
    v_dot2_f32_bf16 v209, v40, s83, v209
    v_dot2_f32_bf16 v210, v40, v40, v210
    v_dot2_f32_bf16 v209, v41, s83, v209
    v_dot2_f32_bf16 v210, v41, v41, v210
    buffer_load_dwordx4 v137, s[16:19], s92 offen offset:1024 lds
    v_dot2_f32_bf16 v209, v42, s83, v209
    v_dot2_f32_bf16 v210, v42, v42, v210
    v_dot2_f32_bf16 v209, v43, s83, v209
    v_dot2_f32_bf16 v210, v43, v43, v210
    v_dot2_f32_bf16 v209, v44, s83, v209
    v_dot2_f32_bf16 v210, v44, v44, v210
    v_dot2_f32_bf16 v209, v45, s83, v209
    v_dot2_f32_bf16 v210, v45, v45, v210
    v_dot2_f32_bf16 v209, v46, s83, v209
    v_dot2_f32_bf16 v210, v46, v46, v210
    v_dot2_f32_bf16 v209, v47, s83, v209
    v_dot2_f32_bf16 v210, v47, v47, v210
    s_waitcnt vmcnt(12)
    s_barrier
    v_mfma_f32_32x32x16_bf16 v[0:15], v[32:35], a[168:171], v[0:15]
    ds_read_b128 v[48:51], v172 offset:32768
    ds_read_b128 v[52:55], v173 offset:32768
    ds_read_b128 v[56:59], v174 offset:32768
    v_accvgpr_write_b32 a80, v32
    v_accvgpr_write_b32 a81, v33
    s_add_u32 s52, s67, s58
    s_add_u32 s28, s67, s76
    v_mfma_f32_32x32x16_bf16 v[16:31], v[32:35], a[172:175], v[16:31]
    ds_read_b128 v[60:63], v175 offset:32768
    ds_read_b128 a[128:131], v176 offset:16384
    ds_read_b128 a[132:135], v176 offset:17408
    v_accvgpr_write_b32 a82, v34
    v_accvgpr_write_b32 a83, v35
    s_xor_b32 s67, s50, 1
    s_mul_i32 s67, s67, 176
    v_mfma_f32_32x32x16_bf16 v[0:15], v[36:39], a[176:179], v[0:15]
    ds_read_b128 a[136:139], v177 offset:16384
    ds_read_b128 a[140:143], v177 offset:17408
    ds_read_b128 a[144:147], v178 offset:16384
    v_accvgpr_write_b32 a84, v36
    v_accvgpr_write_b32 a85, v37
    buffer_load_dwordx4 v138, s[16:19], s92 offen offset:2048 lds
    s_add_u32 s67, s67, s77
    v_mfma_f32_32x32x16_bf16 v[16:31], v[36:39], a[180:183], v[16:31]
    ds_read_b128 a[148:151], v178 offset:17408
    ds_read_b128 a[152:155], v179 offset:16384
    v_accvgpr_write_b32 a86, v38
    v_accvgpr_write_b32 a87, v39
    buffer_load_dwordx4 v139, s[16:19], s92 offen offset:3072 lds
    s_lshl_b32 s67, s67, 10
    v_mfma_f32_32x32x16_bf16 v[0:15], v[40:43], a[184:187], v[0:15]
    ds_read_b128 a[156:159], v179 offset:17408
    ds_read_b128 a[160:163], v180 offset:16384
    v_accvgpr_write_b32 a88, v40
    v_accvgpr_write_b32 a89, v41
    s_add_u32 s55, s67, s58
    s_add_u32 s31, s67, s76
    v_mfma_f32_32x32x16_bf16 v[16:31], v[40:43], a[188:191], v[16:31]
    ds_read_b128 a[164:167], v180 offset:17408
    v_add_u32 v224, s82, v194
    v_accvgpr_write_b32 a90, v42
    v_accvgpr_write_b32 a91, v43
    s_xor_b32 s67, s51, 1
    s_lshl_b32 s57, s67, 15
    v_mfma_f32_32x32x16_bf16 v[0:15], v[44:47], a[192:195], v[0:15]
    ds_write_b128 v224, a[208:211] offset:32768
    ds_write_b128 v224, a[212:215] offset:33792
    v_accvgpr_write_b32 a92, v44
    v_accvgpr_write_b32 a93, v45
    s_add_u32 s57, s57, s78
    s_lshl_b32 s67, s67, 2
    v_mfma_f32_32x32x16_bf16 v[16:31], v[44:47], a[196:199], v[16:31]
    ds_write_b128 v224, a[216:219] offset:34816
    ds_write_b128 v224, a[220:223] offset:35840
    v_accvgpr_write_b32 a94, v46
    v_accvgpr_write_b32 a95, v47
    s_add_u32 s67, s67, s62
    s_mul_i32 s67, s67, 28672
    v_mfma_f32_16x16x32_bf16 v[144:147], v[156:159], a[200:203], v[144:147]
    v_mfma_f32_16x16x32_bf16 v[148:151], v[156:159], a[204:207], v[148:151]
    s_waitcnt lgkmcnt(0)
    v_dot2_f32_bf16 v209, v48, s83, v209
    v_dot2_f32_bf16 v210, v48, v48, v210
    v_dot2_f32_bf16 v209, v49, s83, v209
    v_dot2_f32_bf16 v210, v49, v49, v210
    s_add_u32 m0, s82, 65536
    s_mul_i32 s92, s70, 1792
    s_add_u32 s92, s92, s81
    buffer_load_dwordx4 v136, s[16:19], s92 offen offset:0 lds
    v_dot2_f32_bf16 v209, v50, s83, v209
    v_dot2_f32_bf16 v210, v50, v50, v210
    v_dot2_f32_bf16 v209, v51, s83, v209
    v_dot2_f32_bf16 v210, v51, v51, v210
    v_dot2_f32_bf16 v209, v52, s83, v209
    v_dot2_f32_bf16 v210, v52, v52, v210
    v_dot2_f32_bf16 v209, v53, s83, v209
    v_dot2_f32_bf16 v210, v53, v53, v210
    v_dot2_f32_bf16 v209, v54, s83, v209
    v_dot2_f32_bf16 v210, v54, v54, v210
    v_dot2_f32_bf16 v209, v55, s83, v209
    v_dot2_f32_bf16 v210, v55, v55, v210
    v_dot2_f32_bf16 v209, v56, s83, v209
    v_dot2_f32_bf16 v210, v56, v56, v210
    v_dot2_f32_bf16 v209, v57, s83, v209
    v_dot2_f32_bf16 v210, v57, v57, v210
    buffer_load_dwordx4 v137, s[16:19], s92 offen offset:1024 lds
    v_dot2_f32_bf16 v209, v58, s83, v209
    v_dot2_f32_bf16 v210, v58, v58, v210
    v_dot2_f32_bf16 v209, v59, s83, v209
    v_dot2_f32_bf16 v210, v59, v59, v210
    v_dot2_f32_bf16 v209, v60, s83, v209
    v_dot2_f32_bf16 v210, v60, v60, v210
    v_dot2_f32_bf16 v209, v61, s83, v209
    v_dot2_f32_bf16 v210, v61, v61, v210
    v_dot2_f32_bf16 v209, v62, s83, v209
    v_dot2_f32_bf16 v210, v62, v62, v210
    v_dot2_f32_bf16 v209, v63, s83, v209
    v_dot2_f32_bf16 v210, v63, v63, v210
    s_waitcnt vmcnt(10)
    s_barrier
    v_mfma_f32_32x32x16_bf16 v[0:15], v[48:51], a[128:131], v[0:15]
    ds_read_b128 v[32:35], v172 offset:49152
    ds_read_b128 v[36:39], v173 offset:49152
    ds_read_b128 v[40:43], v174 offset:49152
    v_accvgpr_write_b32 a96, v48
    v_accvgpr_write_b32 a97, v49
    s_add_u32 s67, s67, 12582912
    s_add_u32 s53, s67, s58
    v_mfma_f32_32x32x16_bf16 v[16:31], v[48:51], a[132:135], v[16:31]
    ds_read_b128 v[44:47], v175 offset:49152
    ds_read_b128 a[168:171], v176 offset:18432
    ds_read_b128 a[172:175], v176 offset:19456
    v_accvgpr_write_b32 a98, v50
    v_accvgpr_write_b32 a99, v51
    s_add_u32 s29, s67, s76
    s_bitcmp1_b32 s59, 1
    s_cselect_b64 s[100:101], s[40:41], s[36:37]
    s_cselect_b64 s[40:41], s[36:37], s[40:41]
    s_mov_b64 s[36:37], s[100:101]
    v_mfma_f32_32x32x16_bf16 v[0:15], v[52:55], a[136:139], v[0:15]
    ds_read_b128 a[176:179], v177 offset:18432
    ds_read_b128 a[180:183], v177 offset:19456
    ds_read_b128 a[184:187], v178 offset:18432
    v_accvgpr_write_b32 a100, v52
    v_accvgpr_write_b32 a101, v53
    buffer_load_dwordx4 v138, s[16:19], s92 offen offset:2048 lds
    s_lshl_b32 s48, s51, 6
    v_mfma_f32_32x32x16_bf16 v[16:31], v[52:55], a[140:143], v[16:31]
    ds_read_b128 a[188:191], v178 offset:19456
    ds_read_b128 a[192:195], v179 offset:18432
    ds_read_b128 a[196:199], v179 offset:19456
    v_accvgpr_write_b32 a102, v54
    v_accvgpr_write_b32 a103, v55
    buffer_load_dwordx4 v139, s[16:19], s92 offen offset:3072 lds
    s_lshl_b32 s60, s50, 15
    v_mfma_f32_32x32x16_bf16 v[0:15], v[56:59], a[144:147], v[0:15]
    ds_read_b128 a[200:203], v180 offset:18432
    ds_read_b128 a[204:207], v180 offset:19456
    v_accvgpr_write_b32 a104, v56
    v_accvgpr_write_b32 a105, v57
    s_add_u32 s60, s60, s48
    s_lshl_b32 s61, s50, 8
    v_mfma_f32_32x32x16_bf16 v[16:31], v[56:59], a[148:151], v[16:31]
    s_waitcnt vmcnt(11)
    ds_write_b128 v124, v[96:99] offset:0
    s_waitcnt vmcnt(10)
    ds_write_b128 v124, v[100:103] offset:1024
    v_accvgpr_write_b32 a106, v58
    v_accvgpr_write_b32 a107, v59
    s_lshl_b32 s67, s62, 14
    s_add_u32 s61, s61, s67
    v_mfma_f32_32x32x16_bf16 v[0:15], v[60:63], a[152:155], v[0:15]
    ds_read_b64_tr_b16 v[96:97], v143 offset:0
    ds_read_b64_tr_b16 v[98:99], v143 offset:512
    v_accvgpr_write_b32 a108, v60
    v_accvgpr_write_b32 a109, v61
    s_add_u32 s61, s61, 15859712
    s_lshl_b32 s67, s62, 7
    v_mfma_f32_32x32x16_bf16 v[16:31], v[60:63], a[156:159], v[16:31]
    ds_read_b64_tr_b16 v[100:101], v143 offset:1024
    ds_read_b64_tr_b16 v[102:103], v143 offset:1536
    v_accvgpr_write_b32 a110, v62
    v_accvgpr_write_b32 a111, v63
    s_add_u32 s67, s67, 15925248
    s_lshr_b32 s49, s51, 1
    v_mfma_f32_16x16x32_bf16 v[144:147], v[156:159], a[160:163], v[144:147]
    v_mfma_f32_16x16x32_bf16 v[148:151], v[156:159], a[164:167], v[148:151]
    s_waitcnt lgkmcnt(0)
    v_dot2_f32_bf16 v209, v32, s83, v209
    v_dot2_f32_bf16 v210, v32, v32, v210
    v_dot2_f32_bf16 v209, v33, s83, v209
    v_dot2_f32_bf16 v210, v33, v33, v210
    s_add_u32 m0, s82, 81920
    s_mul_i32 s92, s71, 1792
    s_add_u32 s92, s92, s81
    buffer_load_dwordx4 v136, s[16:19], s92 offen offset:0 lds
    v_dot2_f32_bf16 v209, v34, s83, v209
    v_dot2_f32_bf16 v210, v34, v34, v210
    v_dot2_f32_bf16 v209, v35, s83, v209
    v_dot2_f32_bf16 v210, v35, v35, v210
    v_dot2_f32_bf16 v209, v36, s83, v209
    v_dot2_f32_bf16 v210, v36, v36, v210
    v_dot2_f32_bf16 v209, v37, s83, v209
    v_dot2_f32_bf16 v210, v37, v37, v210
    v_dot2_f32_bf16 v209, v38, s83, v209
    v_dot2_f32_bf16 v210, v38, v38, v210
    v_dot2_f32_bf16 v209, v39, s83, v209
    v_dot2_f32_bf16 v210, v39, v39, v210
    v_dot2_f32_bf16 v209, v40, s83, v209
    v_dot2_f32_bf16 v210, v40, v40, v210
    v_dot2_f32_bf16 v209, v41, s83, v209
    v_dot2_f32_bf16 v210, v41, v41, v210
    buffer_load_dwordx4 v137, s[16:19], s92 offen offset:1024 lds
    v_dot2_f32_bf16 v209, v42, s83, v209
    v_dot2_f32_bf16 v210, v42, v42, v210
    v_dot2_f32_bf16 v209, v43, s83, v209
    v_dot2_f32_bf16 v210, v43, v43, v210
    v_dot2_f32_bf16 v209, v44, s83, v209
    v_dot2_f32_bf16 v210, v44, v44, v210
    v_dot2_f32_bf16 v209, v45, s83, v209
    v_dot2_f32_bf16 v210, v45, v45, v210
    v_dot2_f32_bf16 v209, v46, s83, v209
    v_dot2_f32_bf16 v210, v46, v46, v210
    v_dot2_f32_bf16 v209, v47, s83, v209
    v_dot2_f32_bf16 v210, v47, v47, v210
    v_mfma_f32_32x32x16_bf16 v[0:15], v[32:35], a[168:171], v[0:15]
    v_accvgpr_write_b32 a112, v32
    v_accvgpr_write_b32 a113, v33
    s_lshl_b32 s49, s49, 10
    s_add_u32 s49, s49, s67
    v_mfma_f32_32x32x16_bf16 v[16:31], v[32:35], a[172:175], v[16:31]
    v_accvgpr_write_b32 a114, v34
    v_accvgpr_write_b32 a115, v35
    s_lshr_b32 s3, s50, 2
    s_lshl_b32 s3, s3, 9
    v_mfma_f32_32x32x16_bf16 v[0:15], v[36:39], a[176:179], v[0:15]
    v_accvgpr_write_b32 a116, v36
    v_accvgpr_write_b32 a117, v37
    buffer_load_dwordx4 v138, s[16:19], s92 offen offset:2048 lds
    s_add_u32 s3, s3, s67
    v_mfma_f32_32x32x16_bf16 v[16:31], v[36:39], a[180:183], v[16:31]
    v_accvgpr_write_b32 a118, v38
    v_accvgpr_write_b32 a119, v39
    buffer_load_dwordx4 v139, s[16:19], s92 offen offset:3072 lds
    s_add_u32 s3, s3, 8192
    v_mfma_f32_32x32x16_bf16 v[0:15], v[40:43], a[184:187], v[0:15]
    v_accvgpr_write_b32 a120, v40
    v_accvgpr_write_b32 a121, v41
    buffer_store_dwordx4 v[96:99], v120, s[24:27], 0 offen sc1
    s_movk_i32 s50, 8192
    v_mfma_f32_32x32x16_bf16 v[16:31], v[40:43], a[188:191], v[16:31]
    v_accvgpr_write_b32 a122, v42
    v_accvgpr_write_b32 a123, v43
    buffer_store_dwordx4 v[100:103], v121, s[24:27], 0 offen sc1
    s_movk_i32 s51, 16384
    v_mfma_f32_32x32x16_bf16 v[0:15], v[44:47], a[192:195], v[0:15]
    v_accvgpr_write_b32 a124, v44
    v_accvgpr_write_b32 a125, v45
    v_mfma_f32_32x32x16_bf16 v[16:31], v[44:47], a[196:199], v[16:31]
    v_accvgpr_write_b32 a126, v46
    v_accvgpr_write_b32 a127, v47
    v_mfma_f32_16x16x32_bf16 v[144:147], v[156:159], a[200:203], v[144:147]
    v_mfma_f32_16x16x32_bf16 v[148:151], v[156:159], a[204:207], v[148:151]
Lmark1:
    v_mov_b32 v232, 0
    v_mov_b32 v233, 0
    s_lshl_b32 s77, s62, 9
    s_add_u32 s77, s77, 131072
    v_lshrrev_b32 v234, 1, v194
    v_add_u32 v234, s77, v234
    ds_write_b64 v234, v[232:233]
    v_mov_b32 v224, v209
    v_mov_b32 v225, v210
    ds_write_b32 v218, v144
    ds_write_b32 v218, v148 offset:512
    s_waitcnt lgkmcnt(0)
    s_barrier
    ds_read_b64_tr_b16 a[128:129], v181 offset:32768
    ds_read_b64_tr_b16 a[130:131], v181 offset:33280
    ds_read_b64_tr_b16 a[132:133], v182 offset:32768
    ds_read_b64_tr_b16 a[134:135], v182 offset:33280
    ds_read_b64_tr_b16 a[136:137], v183 offset:32768
    ds_read_b64_tr_b16 a[138:139], v183 offset:33280
    ds_read_b64_tr_b16 a[140:141], v184 offset:32768
    ds_read_b64_tr_b16 a[142:143], v184 offset:33280
    s_waitcnt lgkmcnt(4)
    v_mfma_f32_32x32x16_bf16 v[32:47], a[128:131], a[0:3], 0
    s_add_u32 m0, s82, 98304
    s_mul_i32 s92, s72, 1792
    s_add_u32 s92, s92, s81
    buffer_load_dwordx4 v136, s[16:19], s92 offen offset:0 lds
    ds_read_b64_tr_b16 a[144:145], v181 offset:33792
    ds_read_b64_tr_b16 a[146:147], v181 offset:34304
    v_mfma_f32_16x16x32_bf16 v[152:155], v[156:159], a[128:131], 0
    ds_read_b128 v[236:239], v219
    ds_read_b128 v[240:243], v219 offset:512
    v_mfma_f32_32x32x16_bf16 v[48:63], a[132:135], a[0:3], 0
    ds_read_b64_tr_b16 a[148:149], v182 offset:33792
    ds_read_b64_tr_b16 a[150:151], v182 offset:34304
    v_permlane32_swap_b32 v209, v224
    v_permlane32_swap_b32 v210, v225
    v_add_f32 v209, v209, v224
    v_add_f32 v210, v210, v225
    v_mul_f32 v226, 0x3b000000, v209
    s_waitcnt lgkmcnt(6)
    v_mfma_f32_32x32x16_bf16 v[64:79], a[136:139], a[0:3], 0
    buffer_load_dwordx4 v137, s[16:19], s92 offen offset:1024 lds
    ds_read_b64_tr_b16 a[152:153], v183 offset:33792
    ds_read_b64_tr_b16 a[154:155], v183 offset:34304
    v_mul_f32 v210, 0x3b000000, v210
    v_fma_f32 v210, -v226, v226, v210
    v_max_f32 v210, 0, v210
    v_mfma_f32_32x32x16_bf16 v[80:95], a[140:143], a[0:3], 0
    ds_read_b64_tr_b16 a[156:157], v184 offset:33792
    ds_read_b64_tr_b16 a[158:159], v184 offset:34304
    v_cvt_pk_bf16_f32 v210, v210, v210
    v_and_b32 v210, 0xffff0000, v210
    v_add_f32 v210, 0x3727c5ac, v210
    v_cvt_pk_bf16_f32 v210, v210, v210
    v_and_b32 v210, 0xffff0000, v210
    s_waitcnt lgkmcnt(4)
    v_mfma_f32_32x32x16_bf16 v[32:47], a[144:147], a[4:7], v[32:47]
    buffer_load_dwordx4 v138, s[16:19], s92 offen offset:2048 lds
    ds_read_b64_tr_b16 a[128:129], v181 offset:34816
    ds_read_b64_tr_b16 a[130:131], v181 offset:35328
    v_sqrt_f32 v210, v210
    v_cvt_pk_bf16_f32 v228, v226, v226
    v_mfma_f32_16x16x32_bf16 v[152:155], v[156:159], a[144:147], v[152:155]
    v_and_b32 v228, 0xffff0000, v228
    v_cvt_pk_bf16_f32 v229, v210, v210
    v_mfma_f32_32x32x16_bf16 v[48:63], a[148:151], a[4:7], v[48:63]
    ds_read_b64_tr_b16 a[132:133], v182 offset:34816
    ds_read_b64_tr_b16 a[134:135], v182 offset:35328
    v_and_b32 v229, 0xffff0000, v229
    v_rcp_f32 v209, v229
    v_xor_b32 v224, 0x80000000, v228
    v_lshrrev_b32 v225, 16, v224
    s_waitcnt lgkmcnt(4)
    v_mfma_f32_32x32x16_bf16 v[64:79], a[152:155], a[4:7], v[64:79]
    buffer_load_dwordx4 v139, s[16:19], s92 offen offset:3072 lds
    ds_read_b64_tr_b16 a[136:137], v183 offset:34816
    ds_read_b64_tr_b16 a[138:139], v183 offset:35328
    ds_write_b32 v207, v209
    v_or_b32 v224, v224, v225
    v_cmp_gt_u32 vcc, 32, v223
    v_mov_b32 v196, v229
    v_mul_f32 v195, s93, v209
    v_cndmask_b32 v160, 0, v224, vcc
    v_mfma_f32_32x32x16_bf16 v[80:95], a[156:159], a[4:7], v[80:95]
    ds_read_b64_tr_b16 a[140:141], v184 offset:34816
    ds_read_b64_tr_b16 a[142:143], v184 offset:35328
    v_add_f32 v236, v236, v237
    v_add_f32 v238, v238, v239
    v_add_f32 v236, v236, v238
    v_cvt_pk_bf16_f32 v237, v236, v236
    v_and_b32 v237, 0xffff0000, v237
    s_waitcnt lgkmcnt(5)
    v_mfma_f32_32x32x16_bf16 v[32:47], a[128:131], a[8:11], v[32:47]
    s_add_u32 m0, s82, 114688
    s_mul_i32 s92, s73, 1792
    s_add_u32 s92, s92, s81
    buffer_load_dwordx4 v136, s[16:19], s92 offen offset:0 lds
    ds_read_b64_tr_b16 a[144:145], v181 offset:35840
    ds_read_b64_tr_b16 a[146:147], v181 offset:36352
    v_mfma_f32_16x16x32_bf16 v[152:155], v[156:159], a[128:131], v[152:155]
    s_waitcnt vmcnt(5)
    v_sub_f32 v238, v236, v237
    v_mfma_f32_32x32x16_bf16 v[48:63], a[132:135], a[8:11], v[48:63]
    ds_read_b64_tr_b16 a[148:149], v182 offset:35840
    ds_read_b64_tr_b16 a[150:151], v182 offset:36352
    v_cvt_pk_bf16_f32 v164, v237, v238
    v_add_f32 v240, v240, v241
    v_add_f32 v242, v242, v243
    v_add_f32 v240, v240, v242
    v_cvt_pk_bf16_f32 v241, v240, v240
    s_waitcnt lgkmcnt(4)
    v_mfma_f32_32x32x16_bf16 v[64:79], a[136:139], a[8:11], v[64:79]
    buffer_load_dwordx4 v137, s[16:19], s92 offen offset:1024 lds
    ds_read_b64_tr_b16 a[152:153], v183 offset:35840
    ds_read_b64_tr_b16 a[154:155], v183 offset:36352
    v_and_b32 v241, 0xffff0000, v241
    v_sub_f32 v242, v240, v241
    v_cvt_pk_bf16_f32 v168, v241, v242
    v_mfma_f32_32x32x16_bf16 v[80:95], a[140:143], a[8:11], v[80:95]
    ds_read_b64_tr_b16 a[156:157], v184 offset:35840
    ds_read_b64_tr_b16 a[158:159], v184 offset:36352
    ds_read_b128 v[230:233], v215 offset:0
    ds_read_b128 v[234:237], v215 offset:16
    ds_read_b128 v[238:241], v215 offset:32
    ds_read_b128 v[242:245], v215 offset:48
    s_waitcnt lgkmcnt(8)
    v_mfma_f32_32x32x16_bf16 v[32:47], a[144:147], a[12:15], v[32:47]
    buffer_load_dwordx4 v138, s[16:19], s92 offen offset:2048 lds
    s_barrier
    ds_read_b64_tr_b16 a[128:129], v181 offset:49152
    ds_read_b64_tr_b16 a[130:131], v181 offset:49664
    v_mfma_f32_32x32x16_bf16 v[0:15], v[160:163], v[164:167], v[0:15]
    buffer_store_dword v247, v254, s[24:27], 0 offen offset:0 sc1
    v_mfma_f32_32x32x16_bf16 v[16:31], v[160:163], v[168:171], v[16:31]
    v_sub_f32 v195, 0, v195
    s_lshl_b32 s78, s63, 2
    s_add_u32 s78, s78, s62
    s_mul_i32 s77, s78, 176
    s_lshr_b32 s67, s64, 2
    s_mul_i32 s67, s67, 44
    v_mfma_f32_16x16x32_bf16 v[152:155], v[156:159], a[144:147], v[152:155]
    s_add_u32 s77, s77, s67
    s_add_u32 s77, s77, s65
    v_mfma_f32_32x32x16_bf16 v[48:63], a[148:151], a[12:15], v[48:63]
    buffer_load_dwordx4 v139, s[16:19], s92 offen offset:3072 lds
    ds_read_b64_tr_b16 a[132:133], v182 offset:49152
    ds_read_b64_tr_b16 a[134:135], v182 offset:49664
    s_lshl_b32 s77, s77, 10
    s_mul_i32 s67, s65, 3072
    s_add_u32 s84, s77, s67
    s_add_u32 s84, s84, 16384
    s_waitcnt lgkmcnt(8)
    v_mfma_f32_32x32x16_bf16 v[64:79], a[152:155], a[12:15], v[64:79]
    ds_read_b64_tr_b16 a[136:137], v183 offset:49152
    ds_read_b64_tr_b16 a[138:139], v183 offset:49664
    buffer_store_dwordx2 v[228:229], v221, s[24:27], 0 offen sc1
    v_add_u32 v172, 0xffff0000, v172
    v_add_u32 v173, 0xffff0000, v173
    v_add_u32 v174, 0xffff0000, v174
    v_mfma_f32_32x32x16_bf16 v[80:95], a[156:159], a[12:15], v[80:95]
    s_add_u32 m0, s82, 0
    s_mul_i32 s92, s74, 1792
    s_add_u32 s92, s92, s81
    buffer_load_dwordx4 v136, s[16:19], s92 offen offset:0 lds
    ds_read_b64_tr_b16 a[140:141], v184 offset:49152
    ds_read_b64_tr_b16 a[142:143], v184 offset:49664
    v_add_u32 v175, 0xffff0000, v175
    s_waitcnt lgkmcnt(4)
    v_mfma_f32_32x32x16_bf16 v[32:47], a[128:131], a[16:19], v[32:47]
    ds_read_b64_tr_b16 a[144:145], v181 offset:50176
    ds_read_b64_tr_b16 a[146:147], v181 offset:50688
    v_mov_b32 v189, v142
    v_add_u32 v190, 56320, v142
    v_add_u32 v191, 112640, v142
    v_add_u32 v192, 168960, v142
    v_mfma_f32_16x16x32_bf16 v[152:155], v[156:159], a[128:131], v[152:155]
    v_mul_f32 v0, v0, v230
    v_mul_f32 v16, v16, v230
    v_mfma_f32_32x32x16_bf16 v[48:63], a[132:135], a[16:19], v[48:63]
    buffer_load_dwordx4 v137, s[16:19], s92 offen offset:1024 lds
    ds_read_b64_tr_b16 a[148:149], v182 offset:50176
    ds_read_b64_tr_b16 a[150:151], v182 offset:50688
    v_mul_f32 v1, v1, v231
    v_mul_f32 v17, v17, v231
    v_mul_f32 v2, v2, v232
    v_mul_f32 v18, v18, v232
    s_waitcnt lgkmcnt(4)
    v_mfma_f32_32x32x16_bf16 v[64:79], a[136:139], a[16:19], v[64:79]
    ds_read_b64_tr_b16 a[152:153], v183 offset:50176
    ds_read_b64_tr_b16 a[154:155], v183 offset:50688
    v_mul_f32 v3, v3, v233
    v_mul_f32 v19, v19, v233
    v_mul_f32 v4, v4, v234
    v_mul_f32 v20, v20, v234
    v_mfma_f32_32x32x16_bf16 v[80:95], a[140:143], a[16:19], v[80:95]
    buffer_load_dwordx4 v138, s[16:19], s92 offen offset:2048 lds
    ds_read_b64_tr_b16 a[156:157], v184 offset:50176
    ds_read_b64_tr_b16 a[158:159], v184 offset:50688
    v_mul_f32 v5, v5, v235
    v_mul_f32 v21, v21, v235
    v_mul_f32 v6, v6, v236
    v_mul_f32 v22, v22, v236
    s_waitcnt lgkmcnt(4)
    v_mfma_f32_32x32x16_bf16 v[32:47], a[144:147], a[20:23], v[32:47]
    ds_read_b64_tr_b16 a[128:129], v181 offset:51200
    ds_read_b64_tr_b16 a[130:131], v181 offset:51712
    v_mul_f32 v7, v7, v237
    v_mul_f32 v23, v23, v237
    v_mul_f32 v8, v8, v238
    v_mul_f32 v24, v24, v238
    v_mfma_f32_16x16x32_bf16 v[152:155], v[156:159], a[144:147], v[152:155]
    v_mul_f32 v9, v9, v239
    v_mul_f32 v25, v25, v239
    v_mfma_f32_32x32x16_bf16 v[48:63], a[148:151], a[20:23], v[48:63]
    buffer_load_dwordx4 v139, s[16:19], s92 offen offset:3072 lds
    ds_read_b64_tr_b16 a[132:133], v182 offset:51200
    ds_read_b64_tr_b16 a[134:135], v182 offset:51712
    v_mul_f32 v10, v10, v240
    v_mul_f32 v26, v26, v240
    v_mul_f32 v11, v11, v241
    v_mul_f32 v27, v27, v241
    s_waitcnt lgkmcnt(4)
    v_mfma_f32_32x32x16_bf16 v[64:79], a[152:155], a[20:23], v[64:79]
    ds_read_b64_tr_b16 a[136:137], v183 offset:51200
    ds_read_b64_tr_b16 a[138:139], v183 offset:51712
    v_mul_f32 v12, v12, v242
    v_mul_f32 v28, v28, v242
    v_mul_f32 v13, v13, v243
    v_mul_f32 v29, v29, v243
    v_mfma_f32_32x32x16_bf16 v[80:95], a[156:159], a[20:23], v[80:95]
    s_add_u32 m0, s82, 16384
    s_mul_i32 s92, s75, 1792
    s_add_u32 s92, s92, s81
    buffer_load_dwordx4 v136, s[16:19], s92 offen offset:0 lds
    ds_read_b64_tr_b16 a[140:141], v184 offset:51200
    ds_read_b64_tr_b16 a[142:143], v184 offset:51712
    v_mul_f32 v14, v14, v244
    s_waitcnt lgkmcnt(4)
    v_mfma_f32_32x32x16_bf16 v[32:47], a[128:131], a[24:27], v[32:47]
    ds_read_b64_tr_b16 a[144:145], v181 offset:52224
    ds_read_b64_tr_b16 a[146:147], v181 offset:52736
    v_mul_f32 v30, v30, v244
    v_mul_f32 v15, v15, v245
    v_mul_f32 v31, v31, v245
    v_fma_f32 v224, v197, v0, v1
    v_mfma_f32_16x16x32_bf16 v[152:155], v[156:159], a[128:131], v[152:155]
    v_fma_f32 v225, v197, v16, v17
    v_fma_f32 v224, -v198, v16, v224
    v_mfma_f32_32x32x16_bf16 v[48:63], a[132:135], a[24:27], v[48:63]
    buffer_load_dwordx4 v137, s[16:19], s92 offen offset:1024 lds
    ds_read_b64_tr_b16 a[148:149], v182 offset:52224
    ds_read_b64_tr_b16 a[150:151], v182 offset:52736
    v_fma_f32 v225, v198, v0, v225
    v_fma_f32 v226, v197, v224, v2
    v_fma_f32 v227, v197, v225, v18
    v_fma_f32 v226, -v198, v225, v226
    s_waitcnt lgkmcnt(4)
    v_mfma_f32_32x32x16_bf16 v[64:79], a[136:139], a[24:27], v[64:79]
    ds_read_b64_tr_b16 a[152:153], v183 offset:52224
    ds_read_b64_tr_b16 a[154:155], v183 offset:52736
    v_fma_f32 v227, v198, v224, v227
    v_fma_f32 v224, v197, v226, v3
    v_fma_f32 v225, v197, v227, v19
    v_fma_f32 v224, -v198, v227, v224
    v_mfma_f32_32x32x16_bf16 v[80:95], a[140:143], a[24:27], v[80:95]
    buffer_load_dwordx4 v138, s[16:19], s92 offen offset:2048 lds
    ds_read_b64_tr_b16 a[156:157], v184 offset:52224
    ds_read_b64_tr_b16 a[158:159], v184 offset:52736
    v_fma_f32 v225, v198, v226, v225
    v_fma_f32 v226, v197, v224, v4
    v_fma_f32 v227, v197, v225, v20
    v_fma_f32 v226, -v198, v225, v226
    s_waitcnt lgkmcnt(4)
    v_mfma_f32_32x32x16_bf16 v[32:47], a[144:147], a[28:31], v[32:47]
    s_barrier
    ds_read_b64_tr_b16 a[128:129], v185 offset:0
    ds_read_b64_tr_b16 a[130:131], v185 offset:512
    s_add_u32 s67, s62, 0
    s_and_b32 s67, s67, 3
    v_mfma_f32_16x16x32_bf16 v[152:155], v[156:159], a[144:147], v[152:155]
    v_fma_f32 v227, v198, v224, v227
    v_fma_f32 v224, v197, v226, v5
    v_mfma_f32_32x32x16_bf16 v[48:63], a[148:151], a[28:31], v[48:63]
    buffer_load_dwordx4 v139, s[16:19], s92 offen offset:3072 lds
    ds_read_b64_tr_b16 a[132:133], v186 offset:0
    ds_read_b64_tr_b16 a[134:135], v186 offset:512
    v_fma_f32 v225, v197, v227, v21
    v_fma_f32 v224, -v198, v227, v224
    v_fma_f32 v225, v198, v226, v225
    v_fma_f32 v226, v197, v224, v6
    s_waitcnt lgkmcnt(4)
    v_mfma_f32_32x32x16_bf16 v[64:79], a[152:155], a[28:31], v[64:79]
    ds_read_b64_tr_b16 a[136:137], v187 offset:0
    ds_read_b64_tr_b16 a[138:139], v187 offset:512
    v_fma_f32 v227, v197, v225, v22
    v_fma_f32 v226, -v198, v225, v226
    v_fma_f32 v227, v198, v224, v227
    v_fma_f32 v224, v197, v226, v7
    v_mfma_f32_32x32x16_bf16 v[80:95], a[156:159], a[28:31], v[80:95]
    s_add_u32 m0, s82, 32768
    s_mul_i32 s92, s68, 1792
    s_add_u32 s92, s92, s81
    buffer_load_dwordx4 v189, s[16:19], s92 offen offset:0 lds
    ds_read_b64_tr_b16 a[140:141], v188 offset:0
    ds_read_b64_tr_b16 a[142:143], v188 offset:512
    v_fma_f32 v225, v197, v227, v23
    s_waitcnt lgkmcnt(4)
    v_mfma_f32_32x32x16_bf16 v[32:47], a[128:131], a[32:35], v[32:47]
    ds_read_b64_tr_b16 a[144:145], v185 offset:1024
    ds_read_b64_tr_b16 a[146:147], v185 offset:1536
    v_fma_f32 v224, -v198, v227, v224
    v_fma_f32 v225, v198, v226, v225
    v_fma_f32 v226, v197, v224, v8
    v_fma_f32 v227, v197, v225, v24
    v_mfma_f32_16x16x32_bf16 v[152:155], v[156:159], a[128:131], v[152:155]
    v_fma_f32 v226, -v198, v225, v226
    v_fma_f32 v227, v198, v224, v227
    v_mfma_f32_32x32x16_bf16 v[48:63], a[132:135], a[32:35], v[48:63]
    buffer_load_dwordx4 v190, s[16:19], s92 offen offset:1024 lds
    ds_read_b64_tr_b16 a[148:149], v186 offset:1024
    ds_read_b64_tr_b16 a[150:151], v186 offset:1536
    v_fma_f32 v224, v197, v226, v9
    v_fma_f32 v225, v197, v227, v25
    v_fma_f32 v224, -v198, v227, v224
    v_fma_f32 v225, v198, v226, v225
    s_waitcnt lgkmcnt(4)
    v_mfma_f32_32x32x16_bf16 v[64:79], a[136:139], a[32:35], v[64:79]
    ds_read_b64_tr_b16 a[152:153], v187 offset:1024
    ds_read_b64_tr_b16 a[154:155], v187 offset:1536
    v_fma_f32 v226, v197, v224, v10
    v_fma_f32 v227, v197, v225, v26
    v_fma_f32 v226, -v198, v225, v226
    v_fma_f32 v227, v198, v224, v227
    v_mfma_f32_32x32x16_bf16 v[80:95], a[140:143], a[32:35], v[80:95]
    buffer_load_dwordx4 v191, s[16:19], s92 offen offset:2048 lds
    ds_read_b64_tr_b16 a[156:157], v188 offset:1024
    ds_read_b64_tr_b16 a[158:159], v188 offset:1536
    v_fma_f32 v224, v197, v226, v11
    v_fma_f32 v225, v197, v227, v27
    v_fma_f32 v224, -v198, v227, v224
    v_fma_f32 v225, v198, v226, v225
    s_waitcnt lgkmcnt(4)
    v_mfma_f32_32x32x16_bf16 v[32:47], a[144:147], a[36:39], v[32:47]
    ds_read_b64_tr_b16 a[128:129], v185 offset:2048
    ds_read_b64_tr_b16 a[130:131], v185 offset:2560
    v_fma_f32 v226, v197, v224, v12
    v_fma_f32 v227, v197, v225, v28
    v_fma_f32 v226, -v198, v225, v226
    v_fma_f32 v227, v198, v224, v227
    v_mfma_f32_16x16x32_bf16 v[152:155], v[156:159], a[144:147], v[152:155]
    v_fma_f32 v224, v197, v226, v13
    v_fma_f32 v225, v197, v227, v29
    v_mfma_f32_32x32x16_bf16 v[48:63], a[148:151], a[36:39], v[48:63]
    buffer_load_dwordx4 v192, s[16:19], s92 offen offset:3072 lds
    ds_read_b64_tr_b16 a[132:133], v186 offset:2048
    ds_read_b64_tr_b16 a[134:135], v186 offset:2560
    v_fma_f32 v224, -v198, v227, v224
    v_fma_f32 v225, v198, v226, v225
    v_fma_f32 v226, v197, v224, v14
    v_fma_f32 v227, v197, v225, v30
    s_waitcnt lgkmcnt(4)
    v_mfma_f32_32x32x16_bf16 v[64:79], a[152:155], a[36:39], v[64:79]
    ds_read_b64_tr_b16 a[136:137], v187 offset:2048
    ds_read_b64_tr_b16 a[138:139], v187 offset:2560
    v_fma_f32 v226, -v198, v225, v226
    v_fma_f32 v227, v198, v224, v227
    v_fma_f32 v224, v197, v226, v15
    v_fma_f32 v225, v197, v227, v31
    v_mfma_f32_32x32x16_bf16 v[80:95], a[156:159], a[36:39], v[80:95]
    ds_read_b64_tr_b16 a[140:141], v188 offset:2048
    ds_read_b64_tr_b16 a[142:143], v188 offset:2560
    v_fma_f32 v224, -v198, v227, v224
    v_fma_f32 v225, v198, v226, v225
    ds_write_b64 v213, v[224:225]
    s_lshl_b32 s67, s67, 12
    s_add_u32 s85, s77, s67
    s_waitcnt lgkmcnt(5)
    v_mfma_f32_32x32x16_bf16 v[32:47], a[128:131], a[40:43], v[32:47]
    ds_read_b64_tr_b16 a[144:145], v185 offset:3072
    ds_read_b64_tr_b16 a[146:147], v185 offset:3584
    s_waitcnt lgkmcnt(2)
    s_barrier
    ds_read_b64 v[232:233], v214 offset:0
    ds_read_b64 v[234:235], v214 offset:256
    v_mfma_f32_16x16x32_bf16 v[152:155], v[156:159], a[128:131], v[152:155]
    ds_read_b64 v[236:237], v214 offset:512
    ds_read_b64 v[238:239], v214 offset:768
    v_mfma_f32_32x32x16_bf16 v[48:63], a[132:135], a[40:43], v[48:63]
    s_add_u32 m0, s82, 49152
    s_mul_i32 s92, s69, 1792
    s_add_u32 s92, s92, s81
    buffer_load_dwordx4 v189, s[16:19], s92 offen offset:0 lds
    ds_read_b64_tr_b16 a[148:149], v186 offset:3072
    ds_read_b64_tr_b16 a[150:151], v186 offset:3584
    ds_read_b64 v[240:241], v214 offset:1024
    v_mfma_f32_32x32x16_bf16 v[64:79], a[136:139], a[40:43], v[64:79]
    ds_read_b64_tr_b16 a[152:153], v187 offset:3072
    ds_read_b64_tr_b16 a[154:155], v187 offset:3584
    ds_read_b64 v[242:243], v214 offset:1280
    ds_read_b64 v[244:245], v214 offset:1536
    s_add_u32 s67, s62, 1
    s_and_b32 s67, s67, 3
    v_mfma_f32_32x32x16_bf16 v[80:95], a[140:143], a[40:43], v[80:95]
    buffer_load_dwordx4 v190, s[16:19], s92 offen offset:1024 lds
    ds_read_b64_tr_b16 a[156:157], v188 offset:3072
    ds_read_b64_tr_b16 a[158:159], v188 offset:3584
    s_lshl_b32 s67, s67, 12
    s_add_u32 s86, s77, s67
    s_add_u32 s67, s62, 2
    s_and_b32 s67, s67, 3
    s_waitcnt lgkmcnt(7)
    v_mfma_f32_32x32x16_bf16 v[32:47], a[144:147], a[44:47], v[32:47]
    s_barrier
    ds_read_b64_tr_b16 a[128:129], v185 offset:16384
    ds_read_b64_tr_b16 a[130:131], v185 offset:16896
    s_lshl_b32 s67, s67, 12
    s_add_u32 s87, s77, s67
    v_mfma_f32_16x16x32_bf16 v[152:155], v[156:159], a[144:147], v[152:155]
    v_fma_f32 v234, v199, v232, v234
    v_fma_f32 v235, v199, v233, v235
    v_mfma_f32_32x32x16_bf16 v[48:63], a[148:151], a[44:47], v[48:63]
    buffer_load_dwordx4 v191, s[16:19], s92 offen offset:2048 lds
    ds_read_b64_tr_b16 a[132:133], v186 offset:16384
    ds_read_b64_tr_b16 a[134:135], v186 offset:16896
    v_fma_f32 v234, -v200, v233, v234
    v_fma_f32 v235, v200, v232, v235
    v_fma_f32 v236, v199, v234, v236
    v_fma_f32 v237, v199, v235, v237
    s_waitcnt lgkmcnt(4)
    v_mfma_f32_32x32x16_bf16 v[64:79], a[152:155], a[44:47], v[64:79]
    ds_read_b64_tr_b16 a[136:137], v187 offset:16384
    ds_read_b64_tr_b16 a[138:139], v187 offset:16896
    v_fma_f32 v236, -v200, v235, v236
    v_fma_f32 v237, v200, v234, v237
    v_fma_f32 v238, v199, v236, v238
    v_fma_f32 v239, v199, v237, v239
    v_mfma_f32_32x32x16_bf16 v[80:95], a[156:159], a[44:47], v[80:95]
    buffer_load_dwordx4 v192, s[16:19], s92 offen offset:3072 lds
    ds_read_b64_tr_b16 a[140:141], v188 offset:16384
    ds_read_b64_tr_b16 a[142:143], v188 offset:16896
    v_fma_f32 v238, -v200, v237, v238
    v_fma_f32 v239, v200, v236, v239
    v_fma_f32 v240, v199, v238, v240
    v_fma_f32 v241, v199, v239, v241
    s_waitcnt lgkmcnt(4)
    v_mfma_f32_32x32x16_bf16 v[32:47], a[128:131], a[48:51], v[32:47]
    ds_read_b64_tr_b16 a[144:145], v185 offset:17408
    ds_read_b64_tr_b16 a[146:147], v185 offset:17920
    v_fma_f32 v240, -v200, v239, v240
    v_fma_f32 v241, v200, v238, v241
    v_fma_f32 v242, v199, v240, v242
    v_fma_f32 v243, v199, v241, v243
    v_mfma_f32_16x16x32_bf16 v[152:155], v[156:159], a[128:131], v[152:155]
    v_fma_f32 v242, -v200, v241, v242
    v_fma_f32 v243, v200, v240, v243
    v_mfma_f32_32x32x16_bf16 v[48:63], a[132:135], a[48:51], v[48:63]
    ds_read_b64_tr_b16 a[148:149], v186 offset:17408
    ds_read_b64_tr_b16 a[150:151], v186 offset:17920
    v_fma_f32 v207, v199, v242, v244
    v_fma_f32 v208, v199, v243, v245
    v_fma_f32 v207, -v200, v243, v207
    v_fma_f32 v208, v200, v242, v208
    v_mov_b32 v229, v247
    s_waitcnt lgkmcnt(4)
    v_mfma_f32_32x32x16_bf16 v[64:79], a[136:139], a[48:51], v[64:79]
    ds_read_b64_tr_b16 a[152:153], v187 offset:17408
    ds_read_b64_tr_b16 a[154:155], v187 offset:17920
    v_mov_b32 v231, v247
    v_fma_f32 v228, v199, v207, v224
    v_fma_f32 v230, v199, v208, v225
    v_fma_f32 v228, -v200, v208, v228
    v_mfma_f32_32x32x16_bf16 v[80:95], a[140:143], a[48:51], v[80:95]
    ds_read_b64_tr_b16 a[156:157], v188 offset:17408
    ds_read_b64_tr_b16 a[158:159], v188 offset:17920
    v_fma_f32 v230, v200, v207, v230
    buffer_store_dwordx4 v[228:231], v211, s[32:35], 0 offen sc1
    s_lshl_b32 s79, s59, 10
    v_add_u32 v213, s79, v194
    s_sub_u32 s93, s52, s58
    s_waitcnt lgkmcnt(4)
    v_mfma_f32_32x32x16_bf16 v[32:47], a[144:147], a[52:55], v[32:47]
    ds_read_b64_tr_b16 a[128:129], v185 offset:18432
    ds_read_b64_tr_b16 a[130:131], v185 offset:18944
    s_sub_u32 s94, s53, s58
    v_xor_b32 v214, 1024, v213
    v_xor_b32 v215, 2048, v213
    v_mfma_f32_16x16x32_bf16 v[152:155], v[156:159], a[144:147], v[152:155]
    v_xor_b32 v219, 3072, v213
    v_and_b32 v244, 3, v223
    v_mfma_f32_32x32x16_bf16 v[48:63], a[148:151], a[52:55], v[48:63]
    ds_read_b64_tr_b16 a[132:133], v186 offset:18432
    ds_read_b64_tr_b16 a[134:135], v186 offset:18944
    v_lshlrev_b32 v244, 2, v244
    v_bfe_u32 v245, v223, 2, 1
    v_lshl_add_u32 v245, v245, 9, v244
    s_add_u32 s67, s62, 3
    s_waitcnt lgkmcnt(4)
    v_mfma_f32_32x32x16_bf16 v[64:79], a[152:155], a[52:55], v[64:79]
    ds_read_b64_tr_b16 a[136:137], v187 offset:18432
    ds_read_b64_tr_b16 a[138:139], v187 offset:18944
    buffer_load_dword v246, v245, s[24:27], s49 offen sc1
    s_and_b32 s67, s67, 3
    s_lshl_b32 s67, s67, 12
    v_mfma_f32_32x32x16_bf16 v[80:95], a[156:159], a[52:55], v[80:95]
    ds_read_b64_tr_b16 a[140:141], v188 offset:18432
    ds_read_b64_tr_b16 a[142:143], v188 offset:18944
    s_add_u32 s88, s77, s67
    s_add_u32 s77, s77, 32768
    s_lshl_b32 s67, s62, 2
    s_lshr_b32 s67, 528, s67
    s_waitcnt lgkmcnt(4)
    v_mfma_f32_32x32x16_bf16 v[32:47], a[128:131], a[56:59], v[32:47]
    ds_read_b64_tr_b16 a[144:145], v185 offset:19456
    ds_read_b64_tr_b16 a[146:147], v185 offset:19968
    s_and_b32 s96, s67, 3
    s_lshl_b32 s67, s96, 12
    s_add_u32 s89, s77, s67
    v_mfma_f32_16x16x32_bf16 v[152:155], v[156:159], a[128:131], v[152:155]
    s_lshl_b32 s67, s62, 2
    s_lshr_b32 s67, 4129, s67
    v_mfma_f32_32x32x16_bf16 v[48:63], a[132:135], a[56:59], v[48:63]
    ds_read_b64_tr_b16 a[148:149], v186 offset:19456
    ds_read_b64_tr_b16 a[150:151], v186 offset:19968
    s_and_b32 s97, s67, 3
    s_lshl_b32 s67, s97, 12
    s_add_u32 s90, s77, s67
    s_lshl_b32 s67, s62, 2
    s_waitcnt lgkmcnt(4)
    v_mfma_f32_32x32x16_bf16 v[64:79], a[136:139], a[56:59], v[64:79]
    ds_read_b64_tr_b16 a[152:153], v187 offset:19456
    ds_read_b64_tr_b16 a[154:155], v187 offset:19968
    s_lshr_b32 s67, 8450, s67
    s_and_b32 s98, s67, 3
    s_lshl_b32 s67, s98, 12
    v_mfma_f32_32x32x16_bf16 v[80:95], a[140:143], a[56:59], v[80:95]
    ds_read_b64_tr_b16 a[156:157], v188 offset:19456
    ds_read_b64_tr_b16 a[158:159], v188 offset:19968
    s_add_u32 s91, s77, s67
    s_load_dwordx2 s[20:21], s[0:1], 64
    v_mul_f32 v228, v206, v16
    v_mul_f32 v229, v206, v0
    s_waitcnt lgkmcnt(0)
    v_mfma_f32_32x32x16_bf16 v[32:47], a[144:147], a[60:63], v[32:47]
    s_waitcnt vmcnt(24)
    s_barrier
    ds_read_b64_tr_b16 a[128:129], v185 offset:32768
    ds_read_b64_tr_b16 a[130:131], v185 offset:33280
    v_mfma_f32_16x16x32_bf16 v[152:155], v[156:159], a[144:147], v[152:155]
    v_fma_f32 v0, v205, v0, -v228
    v_fma_f32 v16, v205, v16, v229
    v_mfma_f32_32x32x16_bf16 v[48:63], a[148:151], a[60:63], v[48:63]
    s_add_u32 m0, s82, 65536
    s_mul_i32 s92, s70, 1792
    s_add_u32 s92, s92, s81
    buffer_load_dwordx4 v189, s[16:19], s92 offen offset:0 lds
    ds_read_b64_tr_b16 a[132:133], v186 offset:32768
    ds_read_b64_tr_b16 a[134:135], v186 offset:33280
    v_mfma_f32_32x32x16_bf16 v[64:79], a[152:155], a[60:63], v[64:79]
    ds_read_b64_tr_b16 a[136:137], v187 offset:32768
    ds_read_b64_tr_b16 a[138:139], v187 offset:33280
    v_mul_f32 v230, v206, v17
    v_mul_f32 v231, v206, v1
    v_fma_f32 v1, v205, v1, -v230
    v_mfma_f32_32x32x16_bf16 v[80:95], a[156:159], a[60:63], v[80:95]
    buffer_load_dwordx4 v190, s[16:19], s92 offen offset:1024 lds
    ds_read_b64_tr_b16 a[140:141], v188 offset:32768
    ds_read_b64_tr_b16 a[142:143], v188 offset:33280
    v_fma_f32 v17, v205, v17, v231
    v_mul_f32 v228, v206, v18
    v_mul_f32 v229, v206, v2
    s_waitcnt lgkmcnt(4)
    v_mfma_f32_32x32x16_bf16 v[32:47], a[128:131], a[64:67], v[32:47]
    ds_read_b64_tr_b16 a[144:145], v185 offset:33792
    ds_read_b64_tr_b16 a[146:147], v185 offset:34304
    v_fma_f32 v2, v205, v2, -v228
    v_fma_f32 v18, v205, v18, v229
    v_mul_f32 v230, v206, v19
    v_mfma_f32_16x16x32_bf16 v[152:155], v[156:159], a[128:131], v[152:155]
    v_mul_f32 v231, v206, v3
    v_fma_f32 v3, v205, v3, -v230
    v_mfma_f32_32x32x16_bf16 v[48:63], a[132:135], a[64:67], v[48:63]
    buffer_load_dwordx4 v191, s[16:19], s92 offen offset:2048 lds
    ds_read_b64_tr_b16 a[148:149], v186 offset:33792
    ds_read_b64_tr_b16 a[150:151], v186 offset:34304
    v_fma_f32 v19, v205, v19, v231
    v_mul_f32 v228, v206, v20
    v_mul_f32 v229, v206, v4
    s_waitcnt lgkmcnt(4)
    v_mfma_f32_32x32x16_bf16 v[64:79], a[136:139], a[64:67], v[64:79]
    ds_read_b64_tr_b16 a[152:153], v187 offset:33792
    ds_read_b64_tr_b16 a[154:155], v187 offset:34304
    v_fma_f32 v4, v205, v4, -v228
    v_fma_f32 v20, v205, v20, v229
    v_mul_f32 v230, v206, v21
    v_mfma_f32_32x32x16_bf16 v[80:95], a[140:143], a[64:67], v[80:95]
    buffer_load_dwordx4 v192, s[16:19], s92 offen offset:3072 lds
    ds_read_b64_tr_b16 a[156:157], v188 offset:33792
    ds_read_b64_tr_b16 a[158:159], v188 offset:34304
    v_mul_f32 v231, v206, v5
    v_fma_f32 v5, v205, v5, -v230
    v_fma_f32 v21, v205, v21, v231
    s_waitcnt lgkmcnt(4)
    v_mfma_f32_32x32x16_bf16 v[32:47], a[144:147], a[68:71], v[32:47]
    ds_read_b64_tr_b16 a[128:129], v185 offset:34816
    ds_read_b64_tr_b16 a[130:131], v185 offset:35328
    v_mul_f32 v228, v206, v22
    v_mul_f32 v229, v206, v6
    v_fma_f32 v6, v205, v6, -v228
    v_mfma_f32_16x16x32_bf16 v[152:155], v[156:159], a[144:147], v[152:155]
    v_fma_f32 v22, v205, v22, v229
    v_mul_f32 v230, v206, v23
    v_mfma_f32_32x32x16_bf16 v[48:63], a[148:151], a[68:71], v[48:63]
    ds_read_b64_tr_b16 a[132:133], v186 offset:34816
    ds_read_b64_tr_b16 a[134:135], v186 offset:35328
    v_mul_f32 v231, v206, v7
    v_fma_f32 v7, v205, v7, -v230
    v_fma_f32 v23, v205, v23, v231
    v_mul_f32 v228, v206, v24
    s_waitcnt lgkmcnt(4)
    v_mfma_f32_32x32x16_bf16 v[64:79], a[152:155], a[68:71], v[64:79]
    ds_read_b64_tr_b16 a[136:137], v187 offset:34816
    ds_read_b64_tr_b16 a[138:139], v187 offset:35328
    s_waitcnt vmcnt(4)
    v_cmp_ne_u32 vcc, s99, v246
    s_nop 3
    s_cbranch_vccnz Lretry0
Lback0:
    v_mul_f32 v229, v206, v8
    v_mfma_f32_32x32x16_bf16 v[80:95], a[156:159], a[68:71], v[80:95]
    buffer_load_dwordx4 a[160:163], v213, s[24:27], s52 offen sc1
    ds_read_b64_tr_b16 a[140:141], v188 offset:34816
    ds_read_b64_tr_b16 a[142:143], v188 offset:35328
    v_fma_f32 v8, v205, v8, -v228
    v_fma_f32 v24, v205, v24, v229
    v_mul_f32 v230, v206, v25
    s_waitcnt lgkmcnt(4)
    v_mfma_f32_32x32x16_bf16 v[32:47], a[128:131], a[72:75], v[32:47]
    ds_read_b64_tr_b16 a[144:145], v185 offset:35840
    ds_read_b64_tr_b16 a[146:147], v185 offset:36352
    v_mul_f32 v231, v206, v9
    v_fma_f32 v9, v205, v9, -v230
    v_fma_f32 v25, v205, v25, v231
    v_mfma_f32_16x16x32_bf16 v[152:155], v[156:159], a[128:131], v[152:155]
    v_mul_f32 v228, v206, v26
    v_mul_f32 v229, v206, v10
    v_mfma_f32_32x32x16_bf16 v[48:63], a[132:135], a[72:75], v[48:63]
    buffer_load_dwordx4 a[164:167], v213, s[24:27], s53 offen sc1
    ds_read_b64_tr_b16 a[148:149], v186 offset:35840
    ds_read_b64_tr_b16 a[150:151], v186 offset:36352
    v_fma_f32 v10, v205, v10, -v228
    v_fma_f32 v26, v205, v26, v229
    v_mul_f32 v230, v206, v27
    s_waitcnt lgkmcnt(4)
    v_mfma_f32_32x32x16_bf16 v[64:79], a[136:139], a[72:75], v[64:79]
    ds_read_b64_tr_b16 a[152:153], v187 offset:35840
    ds_read_b64_tr_b16 a[154:155], v187 offset:36352
    v_mul_f32 v231, v206, v11
    v_fma_f32 v11, v205, v11, -v230
    v_fma_f32 v27, v205, v27, v231
    v_mfma_f32_32x32x16_bf16 v[80:95], a[140:143], a[72:75], v[80:95]
    buffer_load_dwordx4 a[168:171], v214, s[24:27], s52 offen sc1
    ds_read_b64_tr_b16 a[156:157], v188 offset:35840
    ds_read_b64_tr_b16 a[158:159], v188 offset:36352
    v_mul_f32 v228, v206, v28
    v_mul_f32 v229, v206, v12
    v_fma_f32 v12, v205, v12, -v228
    s_waitcnt lgkmcnt(4)
    v_mfma_f32_32x32x16_bf16 v[32:47], a[144:147], a[76:79], v[32:47]
    s_barrier
    ds_read_b64_tr_b16 a[128:129], v185 offset:49152
    ds_read_b64_tr_b16 a[130:131], v185 offset:49664
    v_mfma_f32_16x16x32_bf16 v[152:155], v[156:159], a[144:147], v[152:155]
    v_fma_f32 v28, v205, v28, v229
    v_mul_f32 v230, v206, v29
    v_mfma_f32_32x32x16_bf16 v[48:63], a[148:151], a[76:79], v[48:63]
    buffer_load_dwordx4 a[172:175], v214, s[24:27], s53 offen sc1
    ds_read_b64_tr_b16 a[132:133], v185 offset:50176
    ds_read_b64_tr_b16 a[134:135], v185 offset:50688
    v_mul_f32 v231, v206, v13
    v_fma_f32 v13, v205, v13, -v230
    v_fma_f32 v29, v205, v29, v231
    s_waitcnt lgkmcnt(4)
    v_mfma_f32_32x32x16_bf16 v[64:79], a[152:155], a[76:79], v[64:79]
    ds_read_b64_tr_b16 a[136:137], v185 offset:51200
    ds_read_b64_tr_b16 a[138:139], v185 offset:51712
    v_mul_f32 v228, v206, v30
    v_mul_f32 v229, v206, v14
    v_fma_f32 v14, v205, v14, -v228
    v_mfma_f32_32x32x16_bf16 v[80:95], a[156:159], a[76:79], v[80:95]
    s_add_u32 m0, s82, 81920
    s_mul_i32 s92, s71, 1792
    s_add_u32 s92, s92, s81
    buffer_load_dwordx4 v189, s[16:19], s92 offen offset:0 lds
    ds_read_b64_tr_b16 a[140:141], v185 offset:52224
    ds_read_b64_tr_b16 a[142:143], v185 offset:52736
    s_waitcnt lgkmcnt(4)
    v_mfma_f32_32x32x16_bf16 v[32:47], a[128:131], a[80:83], v[32:47]
    s_barrier
    ds_read_b64_tr_b16 a[144:145], v181 offset:0
    ds_read_b64_tr_b16 a[146:147], v181 offset:512
    v_mfma_f32_16x16x32_bf16 v[152:155], v[156:159], a[128:131], v[152:155]
    v_fma_f32 v30, v205, v30, v229
    v_mul_f32 v230, v206, v31
    v_mfma_f32_32x32x16_bf16 v[32:47], a[132:135], a[84:87], v[32:47]
    buffer_load_dwordx4 v190, s[16:19], s92 offen offset:1024 lds
    ds_read_b64_tr_b16 a[148:149], v181 offset:1024
    ds_read_b64_tr_b16 a[150:151], v181 offset:1536
    v_mul_f32 v231, v206, v15
    v_fma_f32 v15, v205, v15, -v230
    v_fma_f32 v31, v205, v31, v231
    v_mfma_f32_16x16x32_bf16 v[152:155], v[156:159], a[132:135], v[152:155]
    v_mul_f32 v230, v206, v208
    v_mul_f32 v231, v206, v207
    s_waitcnt lgkmcnt(4)
    v_mfma_f32_32x32x16_bf16 v[32:47], a[136:139], a[88:91], v[32:47]
    ds_read_b64_tr_b16 a[152:153], v181 offset:2048
    ds_read_b64_tr_b16 a[154:155], v181 offset:2560
    v_fma_f32 v207, v205, v207, -v230
    v_fma_f32 v208, v205, v208, v231
    v_lshrrev_b32 v228, 3, v223
    v_mfma_f32_16x16x32_bf16 v[152:155], v[156:159], a[136:139], v[152:155]
    v_and_b32 v229, 7, v223
    v_lshrrev_b32 v230, 1, v228
    v_mfma_f32_32x32x16_bf16 v[32:47], a[140:143], a[92:95], v[32:47]
    buffer_load_dwordx4 v191, s[16:19], s92 offen offset:2048 lds
    ds_read_b64_tr_b16 a[156:157], v181 offset:3072
    ds_read_b64_tr_b16 a[158:159], v181 offset:3584
    v_xor_b32 v230, v229, v230
    v_lshlrev_b32 v230, 4, v230
    v_lshl_add_u32 v176, v228, 10, v230
    v_mfma_f32_16x16x32_bf16 v[152:155], v[156:159], a[140:143], v[152:155]
    v_xor_b32 v177, 64, v176
    v_add_u32 v178, 14336, v176
    s_waitcnt lgkmcnt(4)
    v_mfma_f32_32x32x16_bf16 v[32:47], a[144:147], a[96:99], v[32:47]
    s_barrier
    ds_read_b64_tr_b16 a[128:129], v181 offset:16384
    ds_read_b64_tr_b16 a[130:131], v181 offset:16896
    v_mfma_f32_16x16x32_bf16 v[152:155], v[156:159], a[144:147], v[152:155]
    v_add_u32 v179, 21504, v177
    v_add_u32 v177, 7168, v177
    v_mfma_f32_32x32x16_bf16 v[32:47], a[148:151], a[100:103], v[32:47]
    buffer_load_dwordx4 v192, s[16:19], s92 offen offset:3072 lds
    ds_read_b64_tr_b16 a[132:133], v181 offset:17408
    ds_read_b64_tr_b16 a[134:135], v181 offset:17920
    s_and_b32 s77, s59, 1
    s_lshl_b32 s77, s77, 5
    s_lshr_b32 s78, s58, 6
    s_or_b32 s77, s77, s78
    v_xor_b32 v172, s77, v172
    v_xor_b32 v173, s77, v173
    v_xor_b32 v174, s77, v174
    v_xor_b32 v175, s77, v175
    v_mfma_f32_16x16x32_bf16 v[152:155], v[156:159], a[148:151], v[152:155]
    s_waitcnt lgkmcnt(4)
    v_mfma_f32_32x32x16_bf16 v[32:47], a[152:155], a[104:107], v[32:47]
    ds_read_b64_tr_b16 a[136:137], v181 offset:18432
    ds_read_b64_tr_b16 a[138:139], v181 offset:18944
    v_add_u32 v180, 0x10000, v172
    v_add_u32 v193, 0x10000, v173
    v_add_u32 v209, 0x10000, v174
    v_mfma_f32_16x16x32_bf16 v[152:155], v[156:159], a[152:155], v[152:155]
    v_add_u32 v210, 0x10000, v175
    s_lshl_b32 s77, s96, 7
    v_add_u32 v218, s77, v220
    s_lshl_b32 s77, s62, 7
    v_add_u32 v220, s77, v220
    v_mfma_f32_32x32x16_bf16 v[32:47], a[156:159], a[108:111], v[32:47]
    s_add_u32 m0, s82, 98304
    s_mul_i32 s92, s72, 1792
    s_add_u32 s92, s92, s81
    buffer_load_dwordx4 v189, s[16:19], s92 offen offset:0 lds
    ds_read_b64_tr_b16 a[140:141], v181 offset:19456
    ds_read_b64_tr_b16 a[142:143], v181 offset:19968
    v_mfma_f32_16x16x32_bf16 v[152:155], v[156:159], a[156:159], v[152:155]
    s_lshl_b32 s77, s62, 2
    s_add_u32 s77, s77, s63
    v_lshrrev_b32 v211, 5, v223
    v_add_u32 v211, s77, v211
    s_waitcnt lgkmcnt(4)
    v_mfma_f32_32x32x16_bf16 v[32:47], a[128:131], a[112:115], v[32:47]
    ds_read_b64_tr_b16 a[144:145], v186 offset:49152
    ds_read_b64_tr_b16 a[146:147], v186 offset:49664
    v_add_u32 v211, -12, v211
    v_max_i32 v211, 0, v211
    v_min_i32 v211, 5, v211
    v_mfma_f32_16x16x32_bf16 v[152:155], v[156:159], a[128:131], v[152:155]
    v_and_b32 v211, 6, v211
    v_mul_lo_u32 v211, v211, s99
    v_mfma_f32_32x32x16_bf16 v[32:47], a[132:135], a[116:119], v[32:47]
    buffer_load_dwordx4 v190, s[16:19], s92 offen offset:1024 lds
    ds_read_b64_tr_b16 a[148:149], v186 offset:50176
    ds_read_b64_tr_b16 a[150:151], v186 offset:50688
    v_mul_f32 v199, v253, v253
    v_mul_f32 v200, v252, v253
    v_fma_f32 v199, v252, v252, -v199
    v_mfma_f32_16x16x32_bf16 v[152:155], v[156:159], a[132:135], v[152:155]
    v_add_f32 v200, v200, v200
    s_lshl_b32 s77, s62, 8
    s_add_u32 s77, s77, 131072
    v_lshlrev_b32 v221, 3, v222
    v_add_u32 v144, s77, v221
    s_waitcnt lgkmcnt(4)
    v_mfma_f32_32x32x16_bf16 v[32:47], a[136:139], a[120:123], v[32:47]
    ds_read_b64_tr_b16 a[152:153], v186 offset:51200
    ds_read_b64_tr_b16 a[154:155], v186 offset:51712
    v_add_u32 v221, 131072, v221
    v_mfma_f32_16x16x32_bf16 v[152:155], v[156:159], a[136:139], v[152:155]
    v_mfma_f32_32x32x16_bf16 v[32:47], a[140:143], a[124:127], v[32:47]
    buffer_load_dwordx4 v191, s[16:19], s92 offen offset:2048 lds
    ds_read_b64_tr_b16 a[156:157], v186 offset:52224
    ds_read_b64_tr_b16 a[158:159], v186 offset:52736
    v_mfma_f32_16x16x32_bf16 v[152:155], v[156:159], a[140:143], v[152:155]
    s_waitcnt lgkmcnt(4)
    v_mfma_f32_32x32x16_bf16 v[48:63], a[144:147], a[80:83], v[48:63]
    ds_read_b64_tr_b16 a[128:129], v182 offset:0
    ds_read_b64_tr_b16 a[130:131], v182 offset:512
    v_mfma_f32_32x32x16_bf16 v[48:63], a[148:151], a[84:87], v[48:63]
    buffer_load_dwordx4 v192, s[16:19], s92 offen offset:3072 lds
    ds_read_b64_tr_b16 a[132:133], v182 offset:1024
    ds_read_b64_tr_b16 a[134:135], v182 offset:1536
    s_waitcnt lgkmcnt(4)
    v_mfma_f32_32x32x16_bf16 v[48:63], a[152:155], a[88:91], v[48:63]
    ds_read_b64_tr_b16 a[136:137], v182 offset:2048
    ds_read_b64_tr_b16 a[138:139], v182 offset:2560
    ds_write_b32 v220, v152 offset:0
    ds_write_b32 v220, v152 offset:512
    v_cvt_pk_bf16_f32 v249, v152, v152
    v_mfma_f32_32x32x16_bf16 v[48:63], a[156:159], a[92:95], v[48:63]
    buffer_load_dwordx4 a[176:179], v215, s[24:27], s52 offen sc1
    ds_read_b64_tr_b16 a[140:141], v182 offset:3072
    ds_read_b64_tr_b16 a[142:143], v182 offset:3584
    v_and_b32 v249, 0xffff0000, v249
    v_sub_f32 v250, v152, v249
    v_cvt_pk_bf16_f32 v164, v249, v250
    s_waitcnt lgkmcnt(6)
    v_mfma_f32_32x32x16_bf16 v[48:63], a[128:131], a[96:99], v[48:63]
    ds_read_b64_tr_b16 a[144:145], v182 offset:16384
    ds_read_b64_tr_b16 a[146:147], v182 offset:16896
    v_mfma_f32_32x32x16_bf16 v[32:47], v[164:167], v[160:163], v[32:47]
    v_mfma_f32_32x32x16_bf16 v[48:63], a[132:135], a[100:103], v[48:63]
    buffer_load_dwordx4 a[180:183], v215, s[24:27], s53 offen sc1
    ds_read_b64_tr_b16 a[148:149], v182 offset:17408
    ds_read_b64_tr_b16 a[150:151], v182 offset:17920
    s_waitcnt lgkmcnt(4)
    v_mfma_f32_32x32x16_bf16 v[48:63], a[136:139], a[104:107], v[48:63]
    ds_read_b64_tr_b16 a[152:153], v182 offset:18432
    ds_read_b64_tr_b16 a[154:155], v182 offset:18944
    s_nop 3
    v_mul_f32 v32, v195, v32
    v_mul_f32 v33, v195, v33
    v_mul_f32 v34, v195, v34
    v_mfma_f32_32x32x16_bf16 v[48:63], a[140:143], a[108:111], v[48:63]
    buffer_load_dwordx4 a[184:187], v219, s[24:27], s52 offen sc1
    ds_read_b64_tr_b16 a[156:157], v182 offset:19456
    ds_read_b64_tr_b16 a[158:159], v182 offset:19968
    v_mul_f32 v35, v195, v35
    v_exp_f32 v32, v32
    s_waitcnt lgkmcnt(4)
    v_mfma_f32_32x32x16_bf16 v[48:63], a[144:147], a[112:115], v[48:63]
    ds_read_b64_tr_b16 a[128:129], v187 offset:49152
    ds_read_b64_tr_b16 a[130:131], v187 offset:49664
    v_exp_f32 v33, v33
    v_exp_f32 v34, v34
    v_mfma_f32_32x32x16_bf16 v[48:63], a[148:151], a[116:119], v[48:63]
    buffer_load_dwordx4 a[188:191], v219, s[24:27], s53 offen sc1
    ds_read_b64_tr_b16 a[132:133], v187 offset:50176
    ds_read_b64_tr_b16 a[134:135], v187 offset:50688
    v_exp_f32 v35, v35
    v_fma_f32 v32, v32, v196, v196
    s_waitcnt lgkmcnt(4)
    v_mfma_f32_32x32x16_bf16 v[48:63], a[152:155], a[120:123], v[48:63]
    ds_read_b64_tr_b16 a[136:137], v187 offset:51200
    ds_read_b64_tr_b16 a[138:139], v187 offset:51712
    v_fma_f32 v33, v33, v196, v196
    v_fma_f32 v34, v34, v196, v196
    v_fma_f32 v35, v35, v196, v196
    v_mfma_f32_32x32x16_bf16 v[48:63], a[156:159], a[124:127], v[48:63]
    buffer_load_dwordx4 a[192:195], v213, s[24:27], s28 offen sc1
    ds_read_b64_tr_b16 a[140:141], v187 offset:52224
    ds_read_b64_tr_b16 a[142:143], v187 offset:52736
    v_rcp_f32 v32, v32
    v_rcp_f32 v33, v33
    s_waitcnt lgkmcnt(4)
    v_mfma_f32_32x32x16_bf16 v[64:79], a[128:131], a[80:83], v[64:79]
    ds_read_b64_tr_b16 a[144:145], v183 offset:0
    ds_read_b64_tr_b16 a[146:147], v183 offset:512
    v_rcp_f32 v34, v34
    v_rcp_f32 v35, v35
    v_mfma_f32_32x32x16_bf16 v[64:79], a[132:135], a[84:87], v[64:79]
    buffer_load_dwordx4 a[196:199], v213, s[24:27], s29 offen sc1
    ds_read_b64_tr_b16 a[148:149], v183 offset:1024
    ds_read_b64_tr_b16 a[150:151], v183 offset:1536
    v_mul_f32 v40, v40, v32
    v_mul_f32 v41, v41, v33
    v_mul_f32 v42, v42, v34
    s_waitcnt lgkmcnt(4)
    v_mfma_f32_32x32x16_bf16 v[64:79], a[136:139], a[88:91], v[64:79]
    ds_read_b64_tr_b16 a[152:153], v183 offset:2048
    ds_read_b64_tr_b16 a[154:155], v183 offset:2560
    v_mul_f32 v43, v43, v35
    v_mul_f32 v36, v195, v36
    v_mul_f32 v37, v195, v37
    v_mfma_f32_32x32x16_bf16 v[64:79], a[140:143], a[92:95], v[64:79]
    buffer_load_dwordx4 a[200:203], v214, s[24:27], s28 offen sc1
    ds_read_b64_tr_b16 a[156:157], v183 offset:3072
    ds_read_b64_tr_b16 a[158:159], v183 offset:3584
    v_mul_f32 v38, v195, v38
    v_mul_f32 v39, v195, v39
    v_exp_f32 v36, v36
    s_waitcnt lgkmcnt(4)
    v_mfma_f32_32x32x16_bf16 v[64:79], a[144:147], a[96:99], v[64:79]
    ds_read_b64_tr_b16 a[128:129], v183 offset:16384
    ds_read_b64_tr_b16 a[130:131], v183 offset:16896
    v_exp_f32 v37, v37
    v_exp_f32 v38, v38
    v_mfma_f32_32x32x16_bf16 v[64:79], a[148:151], a[100:103], v[64:79]
    buffer_load_dwordx4 a[204:207], v214, s[24:27], s29 offen sc1
    ds_read_b64_tr_b16 a[132:133], v183 offset:17408
    ds_read_b64_tr_b16 a[134:135], v183 offset:17920
    v_exp_f32 v39, v39
    v_fma_f32 v36, v36, v196, v196
    s_waitcnt lgkmcnt(4)
    v_mfma_f32_32x32x16_bf16 v[64:79], a[152:155], a[104:107], v[64:79]
    ds_read_b64_tr_b16 a[136:137], v183 offset:18432
    ds_read_b64_tr_b16 a[138:139], v183 offset:18944
    v_fma_f32 v37, v37, v196, v196
    v_fma_f32 v38, v38, v196, v196
    v_fma_f32 v39, v39, v196, v196
    v_mfma_f32_32x32x16_bf16 v[64:79], a[156:159], a[108:111], v[64:79]
    buffer_load_dwordx4 a[208:211], v215, s[24:27], s28 offen sc1
    ds_read_b64_tr_b16 a[140:141], v183 offset:19456
    ds_read_b64_tr_b16 a[142:143], v183 offset:19968
    v_rcp_f32 v36, v36
    v_rcp_f32 v37, v37
    s_waitcnt lgkmcnt(4)
    v_mfma_f32_32x32x16_bf16 v[64:79], a[128:131], a[112:115], v[64:79]
    ds_read_b64_tr_b16 a[144:145], v188 offset:49152
    ds_read_b64_tr_b16 a[146:147], v188 offset:49664
    v_rcp_f32 v38, v38
    v_rcp_f32 v39, v39
    v_mfma_f32_32x32x16_bf16 v[64:79], a[132:135], a[116:119], v[64:79]
    buffer_load_dwordx4 a[212:215], v215, s[24:27], s29 offen sc1
    ds_read_b64_tr_b16 a[148:149], v188 offset:50176
    ds_read_b64_tr_b16 a[150:151], v188 offset:50688
    v_mul_f32 v44, v44, v36
    v_mul_f32 v45, v45, v37
    v_mul_f32 v46, v46, v38
    s_waitcnt lgkmcnt(4)
    v_mfma_f32_32x32x16_bf16 v[64:79], a[136:139], a[120:123], v[64:79]
    ds_read_b64_tr_b16 a[152:153], v188 offset:51200
    ds_read_b64_tr_b16 a[154:155], v188 offset:51712
    v_mul_f32 v47, v47, v39
    v_cvt_pk_bf16_f32 v32, v40, v41
    v_cvt_pk_bf16_f32 v33, v42, v43
    v_mfma_f32_32x32x16_bf16 v[64:79], a[140:143], a[124:127], v[64:79]
    buffer_load_dwordx4 a[216:219], v219, s[24:27], s28 offen sc1
    ds_read_b64_tr_b16 a[156:157], v188 offset:52224
    ds_read_b64_tr_b16 a[158:159], v188 offset:52736
    v_cvt_pk_bf16_f32 v34, v44, v45
    v_cvt_pk_bf16_f32 v35, v46, v47
    s_waitcnt lgkmcnt(4)
    v_mfma_f32_32x32x16_bf16 v[80:95], a[144:147], a[80:83], v[80:95]
    ds_read_b64_tr_b16 a[128:129], v184 offset:0
    ds_read_b64_tr_b16 a[130:131], v184 offset:512
    buffer_store_dwordx4 v[32:35], v194, s[24:27], s85 offen sc1
    s_barrier
    v_mfma_f32_32x32x16_bf16 v[80:95], a[148:151], a[84:87], v[80:95]
    buffer_load_dwordx4 a[220:223], v219, s[24:27], s29 offen sc1
    ds_read_b64_tr_b16 a[132:133], v184 offset:1024
    ds_read_b64_tr_b16 a[134:135], v184 offset:1536
    ds_read_b32 v251, v220 offset:128
    s_waitcnt lgkmcnt(5)
    v_mfma_f32_32x32x16_bf16 v[80:95], a[152:155], a[88:91], v[80:95]
    ds_read_b64_tr_b16 a[136:137], v184 offset:2048
    ds_read_b64_tr_b16 a[138:139], v184 offset:2560
    v_mfma_f32_32x32x16_bf16 v[80:95], a[156:159], a[92:95], v[80:95]
    s_add_u32 s92, s52, 8192
    buffer_load_dwordx4 a[224:227], v213, s[24:27], s92 offen sc1
    ds_read_b64_tr_b16 a[140:141], v184 offset:3072
    ds_read_b64_tr_b16 a[142:143], v184 offset:3584
    s_waitcnt lgkmcnt(4)
    v_cvt_pk_bf16_f32 v249, v251, v251
    v_and_b32 v249, 0xffff0000, v249
    v_mfma_f32_32x32x16_bf16 v[80:95], a[128:131], a[96:99], v[80:95]
    ds_read_b64_tr_b16 a[144:145], v184 offset:16384
    ds_read_b64_tr_b16 a[146:147], v184 offset:16896
    v_sub_f32 v250, v251, v249
    v_cvt_pk_bf16_f32 v168, v249, v250
    s_nop 1
    v_mfma_f32_32x32x16_bf16 v[48:63], v[168:171], v[160:163], v[48:63]
    v_mfma_f32_32x32x16_bf16 v[80:95], a[132:135], a[100:103], v[80:95]
    s_add_u32 s92, s53, 8192
    buffer_load_dwordx4 a[228:231], v213, s[24:27], s92 offen sc1
    ds_read_b64_tr_b16 a[148:149], v184 offset:17408
    ds_read_b64_tr_b16 a[150:151], v184 offset:17920
    s_waitcnt lgkmcnt(4)
    v_mfma_f32_32x32x16_bf16 v[80:95], a[136:139], a[104:107], v[80:95]
    ds_read_b64_tr_b16 a[152:153], v184 offset:18432
    ds_read_b64_tr_b16 a[154:155], v184 offset:18944
    s_nop 2
    v_mul_f32 v48, v195, v48
    v_mul_f32 v49, v195, v49
    v_mul_f32 v50, v195, v50
    v_mfma_f32_32x32x16_bf16 v[80:95], a[140:143], a[108:111], v[80:95]
    s_add_u32 s92, s52, 8192
    buffer_load_dwordx4 a[232:235], v214, s[24:27], s92 offen sc1
    ds_read_b64_tr_b16 a[156:157], v184 offset:19456
    ds_read_b64_tr_b16 a[158:159], v184 offset:19968
    v_mul_f32 v51, v195, v51
    v_exp_f32 v48, v48
    s_waitcnt lgkmcnt(4)
    v_mfma_f32_32x32x16_bf16 v[80:95], a[144:147], a[112:115], v[80:95]
    s_lshl_b32 s76, s96, 5
    v_xor_b32 v181, s76, v140
    v_add_u32 v181, v141, v181
    v_add_u32 v185, 0x10000, v181
    s_lshl_b32 s76, s97, 5
    v_xor_b32 v182, s76, v140
    v_add_u32 v182, v141, v182
    v_add_u32 v186, 0x10000, v182
    s_lshl_b32 s76, s98, 5
    v_xor_b32 v183, s76, v140
    v_add_u32 v183, v141, v183
    v_add_u32 v187, 0x10000, v183
    s_barrier
    ds_read_b64_tr_b16 a[128:129], v181 offset:32768
    ds_read_b64_tr_b16 a[130:131], v181 offset:33280
    v_mfma_f32_32x32x16_bf16 v[80:95], a[148:151], a[116:119], v[80:95]
    s_add_u32 s92, s53, 8192
    buffer_load_dwordx4 a[236:239], v214, s[24:27], s92 offen sc1
    ds_read_b64_tr_b16 a[132:133], v182 offset:32768
    ds_read_b64_tr_b16 a[134:135], v182 offset:33280
    v_exp_f32 v49, v49
    s_waitcnt lgkmcnt(4)
    v_mfma_f32_32x32x16_bf16 v[80:95], a[152:155], a[120:123], v[80:95]
    ds_read_b64_tr_b16 a[136:137], v183 offset:32768
    ds_read_b64_tr_b16 a[138:139], v183 offset:33280
    v_exp_f32 v50, v50
    v_exp_f32 v51, v51
    v_mfma_f32_32x32x16_bf16 v[80:95], a[156:159], a[124:127], v[80:95]
    s_add_u32 m0, s82, 114688
    s_mul_i32 s92, s73, 1792
    s_add_u32 s92, s92, s81
    buffer_load_dwordx4 v189, s[16:19], s92 offen offset:0 lds
    ds_read_b64_tr_b16 a[140:141], v181 offset:33792
    ds_read_b64_tr_b16 a[142:143], v181 offset:34304
    s_waitcnt lgkmcnt(4)
    v_mfma_f32_32x32x16_bf16 v[96:111], a[128:131], a[0:3], 0
    ds_read_b64_tr_b16 a[144:145], v182 offset:33792
    ds_read_b64_tr_b16 a[146:147], v182 offset:34304
    v_fma_f32 v48, v48, v196, v196
    v_fma_f32 v49, v49, v196, v196
    v_fma_f32 v50, v50, v196, v196
    v_mfma_f32_16x16x32_bf16 v[152:155], v[156:159], a[128:131], 0
    v_fma_f32 v51, v51, v196, v196
    v_rcp_f32 v48, v48
    v_mfma_f32_32x32x16_bf16 v[112:127], a[132:135], a[0:3], 0
    buffer_load_dwordx4 v190, s[16:19], s92 offen offset:1024 lds
    ds_read_b64_tr_b16 a[148:149], v183 offset:33792
    ds_read_b64_tr_b16 a[150:151], v183 offset:34304
    v_rcp_f32 v49, v49
    v_rcp_f32 v50, v50
    s_waitcnt lgkmcnt(4)
    v_mfma_f32_32x32x16_bf16 v[128:143], a[136:139], a[0:3], 0
    ds_read_b64_tr_b16 a[152:153], v181 offset:34816
    ds_read_b64_tr_b16 a[154:155], v181 offset:35328
    v_rcp_f32 v51, v51
    v_mul_f32 v56, v56, v48
    v_mfma_f32_32x32x16_bf16 v[96:111], a[140:143], a[4:7], v[96:111]
    buffer_load_dwordx4 v191, s[16:19], s92 offen offset:2048 lds
    ds_read_b64_tr_b16 a[156:157], v182 offset:34816
    ds_read_b64_tr_b16 a[158:159], v182 offset:35328
    v_mul_f32 v57, v57, v49
    v_mul_f32 v58, v58, v50
    v_mul_f32 v59, v59, v51
    v_mfma_f32_16x16x32_bf16 v[152:155], v[156:159], a[140:143], v[152:155]
    v_mul_f32 v52, v195, v52
    v_mul_f32 v53, v195, v53
    s_waitcnt lgkmcnt(4)
    v_mfma_f32_32x32x16_bf16 v[112:127], a[144:147], a[4:7], v[112:127]
    ds_read_b64_tr_b16 a[128:129], v183 offset:34816
    ds_read_b64_tr_b16 a[130:131], v183 offset:35328
    v_mul_f32 v54, v195, v54
    v_mul_f32 v55, v195, v55
    v_exp_f32 v52, v52
    v_mfma_f32_32x32x16_bf16 v[128:143], a[148:151], a[4:7], v[128:143]
    buffer_load_dwordx4 v192, s[16:19], s92 offen offset:3072 lds
    ds_read_b64_tr_b16 a[132:133], v181 offset:35840
    ds_read_b64_tr_b16 a[134:135], v181 offset:36352
    v_exp_f32 v53, v53
    v_exp_f32 v54, v54
    s_waitcnt lgkmcnt(4)
    v_mfma_f32_32x32x16_bf16 v[96:111], a[152:155], a[8:11], v[96:111]
    ds_read_b64_tr_b16 a[136:137], v182 offset:35840
    ds_read_b64_tr_b16 a[138:139], v182 offset:36352
    v_exp_f32 v55, v55
    v_fma_f32 v52, v52, v196, v196
    v_mfma_f32_16x16x32_bf16 v[152:155], v[156:159], a[152:155], v[152:155]
    v_fma_f32 v53, v53, v196, v196
    v_fma_f32 v54, v54, v196, v196
    v_mfma_f32_32x32x16_bf16 v[112:127], a[156:159], a[8:11], v[112:127]
    s_add_u32 m0, s82, 0
    s_mul_i32 s92, s74, 1792
    s_add_u32 s92, s92, s81
    buffer_load_dwordx4 v189, s[16:19], s92 offen offset:0 lds
    ds_read_b64_tr_b16 a[140:141], v183 offset:35840
    ds_read_b64_tr_b16 a[142:143], v183 offset:36352
    s_waitcnt lgkmcnt(4)
    v_mfma_f32_32x32x16_bf16 v[128:143], a[128:131], a[8:11], v[128:143]
    ds_read_b64_tr_b16 a[144:145], v181 offset:49152
    ds_read_b64_tr_b16 a[146:147], v181 offset:49664
    v_fma_f32 v55, v55, v196, v196
    v_rcp_f32 v52, v52
    v_mfma_f32_32x32x16_bf16 v[96:111], a[132:135], a[12:15], v[96:111]
    buffer_load_dwordx4 v190, s[16:19], s92 offen offset:1024 lds
    ds_read_b64_tr_b16 a[148:149], v182 offset:49152
    ds_read_b64_tr_b16 a[150:151], v182 offset:49664
    v_rcp_f32 v53, v53
    v_rcp_f32 v54, v54
    v_mfma_f32_16x16x32_bf16 v[152:155], v[156:159], a[132:135], v[152:155]
    v_rcp_f32 v55, v55
    s_waitcnt lgkmcnt(4)
    v_mfma_f32_32x32x16_bf16 v[112:127], a[136:139], a[12:15], v[112:127]
    ds_read_b64_tr_b16 a[152:153], v183 offset:49152
    ds_read_b64_tr_b16 a[154:155], v183 offset:49664
    v_mul_f32 v60, v60, v52
    v_mul_f32 v61, v61, v53
    v_mul_f32 v62, v62, v54
    v_mfma_f32_32x32x16_bf16 v[128:143], a[140:143], a[12:15], v[128:143]
    buffer_load_dwordx4 v191, s[16:19], s92 offen offset:2048 lds
    ds_read_b64_tr_b16 a[156:157], v181 offset:50176
    ds_read_b64_tr_b16 a[158:159], v181 offset:50688
    v_mul_f32 v63, v63, v55
    v_cvt_pk_bf16_f32 v48, v56, v57
    v_cvt_pk_bf16_f32 v49, v58, v59
    s_waitcnt lgkmcnt(4)
    v_mfma_f32_32x32x16_bf16 v[96:111], a[144:147], a[16:19], v[96:111]
    ds_read_b64_tr_b16 a[128:129], v182 offset:50176
    ds_read_b64_tr_b16 a[130:131], v182 offset:50688
    v_cvt_pk_bf16_f32 v50, v60, v61
    v_cvt_pk_bf16_f32 v51, v62, v63
    buffer_store_dwordx4 v[48:51], v194, s[24:27], s86 offen sc1
    v_mfma_f32_16x16x32_bf16 v[152:155], v[156:159], a[144:147], v[152:155]
    ds_read_b32 v251, v220 offset:256
    v_mfma_f32_32x32x16_bf16 v[112:127], a[148:151], a[16:19], v[112:127]
    buffer_load_dwordx4 v192, s[16:19], s92 offen offset:3072 lds
    ds_read_b64_tr_b16 a[132:133], v183 offset:50176
    ds_read_b64_tr_b16 a[134:135], v183 offset:50688
    s_waitcnt lgkmcnt(5)
    v_mfma_f32_32x32x16_bf16 v[128:143], a[152:155], a[16:19], v[128:143]
    ds_read_b64_tr_b16 a[136:137], v181 offset:51200
    ds_read_b64_tr_b16 a[138:139], v181 offset:51712
    v_mfma_f32_32x32x16_bf16 v[96:111], a[156:159], a[20:23], v[96:111]
    s_add_u32 s92, s52, 8192
    buffer_load_dwordx4 a[240:243], v215, s[24:27], s92 offen sc1
    ds_read_b64_tr_b16 a[140:141], v182 offset:51200
    ds_read_b64_tr_b16 a[142:143], v182 offset:51712
    s_waitcnt lgkmcnt(6)
    v_cvt_pk_bf16_f32 v249, v251, v251
    v_and_b32 v249, 0xffff0000, v249
    v_mfma_f32_16x16x32_bf16 v[152:155], v[156:159], a[156:159], v[152:155]
    v_sub_f32 v250, v251, v249
    v_cvt_pk_bf16_f32 v164, v249, v250
    s_waitcnt lgkmcnt(4)
    v_mfma_f32_32x32x16_bf16 v[112:127], a[128:131], a[20:23], v[112:127]
    ds_read_b64_tr_b16 a[144:145], v183 offset:51200
    ds_read_b64_tr_b16 a[146:147], v183 offset:51712
    v_mfma_f32_32x32x16_bf16 v[64:79], v[164:167], v[160:163], v[64:79]
    buffer_load_dwordx4 v[32:35], v212, s[32:35], 0 offen offset:1024 sc1
    v_mfma_f32_32x32x16_bf16 v[128:143], a[132:135], a[20:23], v[128:143]
    s_add_u32 s92, s53, 8192
    buffer_load_dwordx4 a[244:247], v215, s[24:27], s92 offen sc1
    ds_read_b64_tr_b16 a[148:149], v181 offset:52224
    ds_read_b64_tr_b16 a[150:151], v181 offset:52736
    s_waitcnt lgkmcnt(4)
    v_mfma_f32_32x32x16_bf16 v[96:111], a[136:139], a[24:27], v[96:111]
    ds_read_b64_tr_b16 a[152:153], v182 offset:52224
    ds_read_b64_tr_b16 a[154:155], v182 offset:52736
    s_nop 1
    v_mul_f32 v64, v195, v64
    v_mul_f32 v65, v195, v65
    v_mul_f32 v66, v195, v66
    v_mfma_f32_16x16x32_bf16 v[152:155], v[156:159], a[136:139], v[152:155]
    v_mul_f32 v67, v195, v67
    v_exp_f32 v64, v64
    v_mfma_f32_32x32x16_bf16 v[112:127], a[140:143], a[24:27], v[112:127]
    s_add_u32 s92, s52, 8192
    buffer_load_dwordx4 a[248:251], v219, s[24:27], s92 offen sc1
    ds_read_b64_tr_b16 a[156:157], v183 offset:52224
    ds_read_b64_tr_b16 a[158:159], v183 offset:52736
    v_exp_f32 v65, v65
    s_waitcnt lgkmcnt(4)
    v_mfma_f32_32x32x16_bf16 v[128:143], a[144:147], a[24:27], v[128:143]
    s_waitcnt vmcnt(34)
    s_barrier
    ds_read_b64_tr_b16 a[128:129], v185 offset:0
    ds_read_b64_tr_b16 a[130:131], v185 offset:512
    buffer_load_dwordx4 v[36:39], v212, s[32:35], 0 offen offset:0 sc1
    v_mfma_f32_32x32x16_bf16 v[96:111], a[148:151], a[28:31], v[96:111]
    s_add_u32 s92, s53, 8192
    buffer_load_dwordx4 a[252:255], v219, s[24:27], s92 offen sc1
    ds_read_b64_tr_b16 a[132:133], v186 offset:0
    ds_read_b64_tr_b16 a[134:135], v186 offset:512
    v_exp_f32 v66, v66
    v_mfma_f32_16x16x32_bf16 v[152:155], v[156:159], a[148:151], v[152:155]
    v_exp_f32 v67, v67
    s_waitcnt lgkmcnt(4)
    v_mfma_f32_32x32x16_bf16 v[112:127], a[152:155], a[28:31], v[112:127]
    ds_read_b64_tr_b16 a[136:137], v187 offset:0
    ds_read_b64_tr_b16 a[138:139], v187 offset:512
    v_lshrrev_b32 v245, 2, v223
    v_lshl_add_u32 v245, v245, 7, v244
    s_lshl_b32 s79, s62, 11
    s_add_u32 s79, s79, 15925248
    s_cmp_eq_u32 s2, 0
    s_cselect_b32 s79, s79, 1073741824
    s_cselect_b32 s80, s99, 0
    s_cselect_b32 s66, 32768, 1073741824
    v_mfma_f32_32x32x16_bf16 v[128:143], a[156:159], a[28:31], v[128:143]
    s_add_u32 m0, s82, 16384
    s_mul_i32 s92, s75, 1792
    s_add_u32 s92, s92, s81
    buffer_load_dwordx4 v189, s[16:19], s92 offen offset:0 lds
    ds_read_b64_tr_b16 a[140:141], v185 offset:1024
    ds_read_b64_tr_b16 a[142:143], v185 offset:1536
    s_waitcnt lgkmcnt(4)
    v_mfma_f32_32x32x16_bf16 v[96:111], a[128:131], a[32:35], v[96:111]
    ds_read_b64_tr_b16 a[144:145], v186 offset:1024
    ds_read_b64_tr_b16 a[146:147], v186 offset:1536
    buffer_load_dword v246, v245, s[24:27], s79 offen sc1
    v_fma_f32 v64, v64, v196, v196
    v_fma_f32 v65, v65, v196, v196
    v_mfma_f32_16x16x32_bf16 v[152:155], v[156:159], a[128:131], v[152:155]
    v_fma_f32 v66, v66, v196, v196
    v_fma_f32 v67, v67, v196, v196
    v_mfma_f32_32x32x16_bf16 v[112:127], a[132:135], a[32:35], v[112:127]
    buffer_load_dwordx4 v190, s[16:19], s92 offen offset:1024 lds
    ds_read_b64_tr_b16 a[148:149], v187 offset:1024
    ds_read_b64_tr_b16 a[150:151], v187 offset:1536
    v_rcp_f32 v64, v64
    v_rcp_f32 v65, v65
    s_waitcnt lgkmcnt(4)
    v_mfma_f32_32x32x16_bf16 v[128:143], a[136:139], a[32:35], v[128:143]
    ds_read_b64_tr_b16 a[152:153], v185 offset:2048
    ds_read_b64_tr_b16 a[154:155], v185 offset:2560
    v_rcp_f32 v66, v66
    v_rcp_f32 v67, v67
    v_mfma_f32_32x32x16_bf16 v[96:111], a[140:143], a[36:39], v[96:111]
    buffer_load_dwordx4 v191, s[16:19], s92 offen offset:2048 lds
    ds_read_b64_tr_b16 a[156:157], v186 offset:2048
    ds_read_b64_tr_b16 a[158:159], v186 offset:2560
    v_mul_f32 v72, v72, v64
    v_mul_f32 v73, v73, v65
    v_mul_f32 v74, v74, v66
    v_mfma_f32_16x16x32_bf16 v[152:155], v[156:159], a[140:143], v[152:155]
    v_mul_f32 v75, v75, v67
    v_mul_f32 v68, v195, v68
    s_waitcnt lgkmcnt(4)
    v_mfma_f32_32x32x16_bf16 v[112:127], a[144:147], a[36:39], v[112:127]
    ds_read_b64_tr_b16 a[128:129], v187 offset:2048
    ds_read_b64_tr_b16 a[130:131], v187 offset:2560
    v_mul_f32 v69, v195, v69
    v_mul_f32 v70, v195, v70
    v_mul_f32 v71, v195, v71
    v_mfma_f32_32x32x16_bf16 v[128:143], a[148:151], a[36:39], v[128:143]
    buffer_load_dwordx4 v192, s[16:19], s92 offen offset:3072 lds
    ds_read_b64_tr_b16 a[132:133], v185 offset:3072
    ds_read_b64_tr_b16 a[134:135], v185 offset:3584
    v_exp_f32 v68, v68
    v_exp_f32 v69, v69
    s_waitcnt lgkmcnt(4)
    v_mfma_f32_32x32x16_bf16 v[96:111], a[152:155], a[40:43], v[96:111]
    ds_read_b64_tr_b16 a[136:137], v186 offset:3072
    ds_read_b64_tr_b16 a[138:139], v186 offset:3584
    v_exp_f32 v70, v70
    v_exp_f32 v71, v71
    v_mfma_f32_16x16x32_bf16 v[152:155], v[156:159], a[152:155], v[152:155]
    v_fma_f32 v68, v68, v196, v196
    v_mfma_f32_32x32x16_bf16 v[112:127], a[156:159], a[40:43], v[112:127]
    s_add_u32 s92, s28, 8192
    buffer_load_dwordx4 a[0:3], v213, s[24:27], s92 offen sc1
    ds_read_b64_tr_b16 a[140:141], v187 offset:3072
    ds_read_b64_tr_b16 a[142:143], v187 offset:3584
    v_fma_f32 v69, v69, v196, v196
    v_fma_f32 v70, v70, v196, v196
    s_waitcnt lgkmcnt(4)
    v_mfma_f32_32x32x16_bf16 v[128:143], a[128:131], a[40:43], v[128:143]
    ds_read_b64_tr_b16 a[144:145], v185 offset:16384
    ds_read_b64_tr_b16 a[146:147], v185 offset:16896
    v_fma_f32 v71, v71, v196, v196
    v_rcp_f32 v68, v68
    v_mfma_f32_32x32x16_bf16 v[96:111], a[132:135], a[44:47], v[96:111]
    s_add_u32 s92, s29, 8192
    buffer_load_dwordx4 a[4:7], v213, s[24:27], s92 offen sc1
    ds_read_b64_tr_b16 a[148:149], v186 offset:16384
    ds_read_b64_tr_b16 a[150:151], v186 offset:16896
    v_rcp_f32 v69, v69
    v_mfma_f32_16x16x32_bf16 v[152:155], v[156:159], a[132:135], v[152:155]
    v_rcp_f32 v70, v70
    s_waitcnt lgkmcnt(4)
    v_mfma_f32_32x32x16_bf16 v[112:127], a[136:139], a[44:47], v[112:127]
    ds_read_b64_tr_b16 a[152:153], v187 offset:16384
    ds_read_b64_tr_b16 a[154:155], v187 offset:16896
    v_rcp_f32 v71, v71
    v_mul_f32 v76, v76, v68
    v_mfma_f32_32x32x16_bf16 v[128:143], a[140:143], a[44:47], v[128:143]
    s_add_u32 s92, s28, 8192
    buffer_load_dwordx4 a[8:11], v214, s[24:27], s92 offen sc1
    ds_read_b64_tr_b16 a[156:157], v185 offset:17408
    ds_read_b64_tr_b16 a[158:159], v185 offset:17920
    v_mul_f32 v77, v77, v69
    v_mul_f32 v78, v78, v70
    s_waitcnt lgkmcnt(4)
    v_mfma_f32_32x32x16_bf16 v[96:111], a[144:147], a[48:51], v[96:111]
    ds_read_b64_tr_b16 a[128:129], v186 offset:17408
    ds_read_b64_tr_b16 a[130:131], v186 offset:17920
    v_mul_f32 v79, v79, v71
    v_cvt_pk_bf16_f32 v64, v72, v73
    v_cvt_pk_bf16_f32 v65, v74, v75
    v_mfma_f32_16x16x32_bf16 v[152:155], v[156:159], a[144:147], v[152:155]
    v_cvt_pk_bf16_f32 v66, v76, v77
    v_cvt_pk_bf16_f32 v67, v78, v79
    v_mfma_f32_32x32x16_bf16 v[112:127], a[148:151], a[48:51], v[112:127]
    s_add_u32 s92, s29, 8192
    buffer_load_dwordx4 a[12:15], v214, s[24:27], s92 offen sc1
    ds_read_b64_tr_b16 a[132:133], v187 offset:17408
    ds_read_b64_tr_b16 a[134:135], v187 offset:17920
    s_waitcnt lgkmcnt(4)
    v_mfma_f32_32x32x16_bf16 v[128:143], a[152:155], a[48:51], v[128:143]
    ds_read_b64_tr_b16 a[136:137], v185 offset:18432
    ds_read_b64_tr_b16 a[138:139], v185 offset:18944
    buffer_store_dwordx4 v[64:67], v194, s[24:27], s87 offen sc1
    ds_read_b32 v251, v220 offset:384
    v_mfma_f32_32x32x16_bf16 v[96:111], a[156:159], a[52:55], v[96:111]
    s_add_u32 s92, s28, 8192
    buffer_load_dwordx4 a[16:19], v215, s[24:27], s92 offen sc1
    ds_read_b64_tr_b16 a[140:141], v186 offset:18432
    ds_read_b64_tr_b16 a[142:143], v186 offset:18944
    v_mfma_f32_16x16x32_bf16 v[152:155], v[156:159], a[156:159], v[152:155]
    s_waitcnt vmcnt(9)
    v_cmp_ne_u32 vcc, s80, v246
    s_nop 3
    s_cbranch_vccnz Lretry1
Lback1:
    s_waitcnt lgkmcnt(5)
    v_mfma_f32_32x32x16_bf16 v[112:127], a[128:131], a[52:55], v[112:127]
    ds_read_b64_tr_b16 a[144:145], v187 offset:18432
    ds_read_b64_tr_b16 a[146:147], v187 offset:18944
    s_waitcnt lgkmcnt(4)
    v_cvt_pk_bf16_f32 v249, v251, v251
    v_and_b32 v249, 0xffff0000, v249
    v_sub_f32 v250, v251, v249
    v_mfma_f32_32x32x16_bf16 v[128:143], a[132:135], a[52:55], v[128:143]
    s_add_u32 s92, s29, 8192
    buffer_load_dwordx4 a[20:23], v215, s[24:27], s92 offen sc1
    ds_read_b64_tr_b16 a[148:149], v185 offset:19456
    ds_read_b64_tr_b16 a[150:151], v185 offset:19968
    v_cvt_pk_bf16_f32 v168, v249, v250
    s_nop 1
    v_mfma_f32_32x32x16_bf16 v[80:95], v[168:171], v[160:163], v[80:95]
    s_waitcnt lgkmcnt(4)
    v_mfma_f32_32x32x16_bf16 v[96:111], a[136:139], a[56:59], v[96:111]
    s_add_u32 s92, s28, 8192
    buffer_load_dwordx4 a[24:27], v219, s[24:27], s92 offen sc1
    ds_read_b64_tr_b16 a[152:153], v186 offset:19456
    ds_read_b64_tr_b16 a[154:155], v186 offset:19968
    v_mfma_f32_16x16x32_bf16 v[152:155], v[156:159], a[136:139], v[152:155]
    s_nop 4
    v_mul_f32 v80, v195, v80
    v_mul_f32 v81, v195, v81
    v_mfma_f32_32x32x16_bf16 v[112:127], a[140:143], a[56:59], v[112:127]
    ds_read_b64_tr_b16 a[156:157], v187 offset:19456
    ds_read_b64_tr_b16 a[158:159], v187 offset:19968
    v_mul_f32 v82, v195, v82
    v_mul_f32 v83, v195, v83
    v_exp_f32 v80, v80
    s_waitcnt lgkmcnt(4)
    v_mfma_f32_32x32x16_bf16 v[128:143], a[144:147], a[56:59], v[128:143]
    s_add_u32 s92, s29, 8192
    buffer_load_dwordx4 a[28:31], v219, s[24:27], s92 offen sc1
    s_barrier
    ds_read_b64_tr_b16 a[128:129], v185 offset:32768
    ds_read_b64_tr_b16 a[130:131], v185 offset:33280
    v_mfma_f32_32x32x16_bf16 v[96:111], a[148:151], a[60:63], v[96:111]
    ds_read_b64_tr_b16 a[132:133], v186 offset:32768
    ds_read_b64_tr_b16 a[134:135], v186 offset:33280
    v_exp_f32 v81, v81
    v_exp_f32 v82, v82
    v_mfma_f32_16x16x32_bf16 v[152:155], v[156:159], a[148:151], v[152:155]
    v_exp_f32 v83, v83
    s_waitcnt lgkmcnt(4)
    v_mfma_f32_32x32x16_bf16 v[112:127], a[152:155], a[60:63], v[112:127]
    s_add_u32 s92, s52, 16384
    buffer_load_dwordx4 a[32:35], v213, s[24:27], s92 offen sc1
    ds_read_b64_tr_b16 a[136:137], v187 offset:32768
    ds_read_b64_tr_b16 a[138:139], v187 offset:33280
    v_fma_f32 v80, v80, v196, v196
    v_mfma_f32_32x32x16_bf16 v[128:143], a[156:159], a[60:63], v[128:143]
    ds_read_b64_tr_b16 a[140:141], v185 offset:33792
    ds_read_b64_tr_b16 a[142:143], v185 offset:34304
    v_fma_f32 v81, v81, v196, v196
    v_fma_f32 v82, v82, v196, v196
    v_fma_f32 v83, v83, v196, v196
    v_rcp_f32 v80, v80
    s_waitcnt lgkmcnt(4)
    v_mfma_f32_32x32x16_bf16 v[96:111], a[128:131], a[64:67], v[96:111]
    s_add_u32 s92, s53, 16384
    buffer_load_dwordx4 a[36:39], v213, s[24:27], s92 offen sc1
    ds_read_b64_tr_b16 a[144:145], v186 offset:33792
    ds_read_b64_tr_b16 a[146:147], v186 offset:34304
    v_rcp_f32 v81, v81
    v_mfma_f32_16x16x32_bf16 v[152:155], v[156:159], a[128:131], v[152:155]
    v_rcp_f32 v82, v82
    v_mfma_f32_32x32x16_bf16 v[112:127], a[132:135], a[64:67], v[112:127]
    ds_read_b64_tr_b16 a[148:149], v187 offset:33792
    ds_read_b64_tr_b16 a[150:151], v187 offset:34304
    v_rcp_f32 v83, v83
    v_mul_f32 v88, v88, v80
    v_mul_f32 v89, v89, v81
    s_waitcnt lgkmcnt(4)
    v_mfma_f32_32x32x16_bf16 v[128:143], a[136:139], a[64:67], v[128:143]
    s_add_u32 s92, s52, 16384
    buffer_load_dwordx4 a[40:43], v214, s[24:27], s92 offen sc1
    ds_read_b64_tr_b16 a[152:153], v185 offset:34816
    ds_read_b64_tr_b16 a[154:155], v185 offset:35328
    v_mul_f32 v90, v90, v82
    v_mfma_f32_32x32x16_bf16 v[96:111], a[140:143], a[68:71], v[96:111]
    ds_read_b64_tr_b16 a[156:157], v186 offset:34816
    ds_read_b64_tr_b16 a[158:159], v186 offset:35328
    v_mul_f32 v91, v91, v83
    v_mul_f32 v84, v195, v84
    v_mul_f32 v85, v195, v85
    v_mul_f32 v86, v195, v86
    v_mfma_f32_16x16x32_bf16 v[152:155], v[156:159], a[140:143], v[152:155]
    v_mul_f32 v87, v195, v87
    v_exp_f32 v84, v84
    s_waitcnt lgkmcnt(4)
    v_mfma_f32_32x32x16_bf16 v[112:127], a[144:147], a[68:71], v[112:127]
    s_add_u32 s92, s53, 16384
    buffer_load_dwordx4 a[44:47], v214, s[24:27], s92 offen sc1
    ds_read_b64_tr_b16 a[128:129], v187 offset:34816
    ds_read_b64_tr_b16 a[130:131], v187 offset:35328
    v_exp_f32 v85, v85
    v_mfma_f32_32x32x16_bf16 v[128:143], a[148:151], a[68:71], v[128:143]
    ds_read_b64_tr_b16 a[132:133], v185 offset:35840
    ds_read_b64_tr_b16 a[134:135], v185 offset:36352
    v_exp_f32 v86, v86
    v_exp_f32 v87, v87
    s_waitcnt lgkmcnt(4)
    v_mfma_f32_32x32x16_bf16 v[96:111], a[152:155], a[72:75], v[96:111]
    s_add_u32 s92, s52, 16384
    buffer_load_dwordx4 a[48:51], v215, s[24:27], s92 offen sc1
    ds_read_b64_tr_b16 a[136:137], v186 offset:35840
    ds_read_b64_tr_b16 a[138:139], v186 offset:36352
    v_fma_f32 v84, v84, v196, v196
    v_mfma_f32_16x16x32_bf16 v[152:155], v[156:159], a[152:155], v[152:155]
    v_fma_f32 v85, v85, v196, v196
    v_fma_f32 v86, v86, v196, v196
    v_mfma_f32_32x32x16_bf16 v[112:127], a[156:159], a[72:75], v[112:127]
    ds_read_b64_tr_b16 a[140:141], v187 offset:35840
    ds_read_b64_tr_b16 a[142:143], v187 offset:36352
    v_fma_f32 v87, v87, v196, v196
    v_rcp_f32 v84, v84
    v_rcp_f32 v85, v85
    s_waitcnt lgkmcnt(4)
    v_mfma_f32_32x32x16_bf16 v[128:143], a[128:131], a[72:75], v[128:143]
    s_add_u32 s92, s53, 16384
    buffer_load_dwordx4 a[52:55], v215, s[24:27], s92 offen sc1
    ds_read_b64_tr_b16 a[144:145], v185 offset:49152
    ds_read_b64_tr_b16 a[146:147], v185 offset:49664
    v_rcp_f32 v86, v86
    v_mfma_f32_32x32x16_bf16 v[96:111], a[132:135], a[76:79], v[96:111]
    ds_read_b64_tr_b16 a[148:149], v186 offset:49152
    ds_read_b64_tr_b16 a[150:151], v186 offset:49664
    v_rcp_f32 v87, v87
    v_mul_f32 v92, v92, v84
    v_mul_f32 v93, v93, v85
    v_mfma_f32_16x16x32_bf16 v[152:155], v[156:159], a[132:135], v[152:155]
    v_mul_f32 v94, v94, v86
    v_mul_f32 v95, v95, v87
    s_waitcnt lgkmcnt(4)
    v_mfma_f32_32x32x16_bf16 v[112:127], a[136:139], a[76:79], v[112:127]
    s_add_u32 s92, s52, 16384
    buffer_load_dwordx4 a[56:59], v219, s[24:27], s92 offen sc1
    ds_read_b64_tr_b16 a[152:153], v187 offset:49152
    ds_read_b64_tr_b16 a[154:155], v187 offset:49664
    v_cvt_pk_bf16_f32 v80, v88, v89
    v_mfma_f32_32x32x16_bf16 v[128:143], a[140:143], a[76:79], v[128:143]
    ds_read_b64_tr_b16 a[156:157], v185 offset:50176
    ds_read_b64_tr_b16 a[158:159], v185 offset:50688
    v_cvt_pk_bf16_f32 v81, v90, v91
    v_cvt_pk_bf16_f32 v82, v92, v93
    v_cvt_pk_bf16_f32 v83, v94, v95
    buffer_store_dwordx4 v[80:83], v194, s[24:27], s88 offen sc1
    s_waitcnt lgkmcnt(4)
    v_mfma_f32_32x32x16_bf16 v[96:111], a[144:147], a[80:83], v[96:111]
    s_add_u32 s92, s53, 16384
    buffer_load_dwordx4 a[60:63], v219, s[24:27], s92 offen sc1
    ds_read_b64_tr_b16 a[128:129], v186 offset:50176
    ds_read_b64_tr_b16 a[130:131], v186 offset:50688
    v_add_u32 v240, v33, v35
    v_mfma_f32_16x16x32_bf16 v[152:155], v[156:159], a[144:147], v[152:155]
    v_add3_u32 v240, v240, v37, v39
    v_cmp_ne_u32 vcc, v211, v240
    s_nop 3
    s_cbranch_vccnz Lretry2
Lback2:
    v_mfma_f32_32x32x16_bf16 v[112:127], a[148:151], a[80:83], v[112:127]
    ds_read_b64_tr_b16 a[132:133], v187 offset:50176
    ds_read_b64_tr_b16 a[134:135], v187 offset:50688
    v_fma_f32 v36, v252, v32, v36
    v_fma_f32 v38, v252, v34, v38
    v_fma_f32 v36, -v253, v34, v36
    v_fma_f32 v38, v253, v32, v38
    s_waitcnt lgkmcnt(4)
    v_mfma_f32_32x32x16_bf16 v[128:143], a[152:155], a[80:83], v[128:143]
    s_add_u32 s92, s28, 16384
    buffer_load_dwordx4 a[64:67], v213, s[24:27], s92 offen sc1
    ds_read_b64_tr_b16 a[136:137], v185 offset:51200
    ds_read_b64_tr_b16 a[138:139], v185 offset:51712
    v_mov_b32 v240, v36
    v_mfma_f32_32x32x16_bf16 v[96:111], a[156:159], a[84:87], v[96:111]
    ds_read_b64_tr_b16 a[140:141], v186 offset:51200
    ds_read_b64_tr_b16 a[142:143], v186 offset:51712
    v_mov_b32 v241, v38
    s_nop 0
    v_permlane32_swap_b32 v36, v240
    v_permlane32_swap_b32 v38, v241
    v_mfma_f32_16x16x32_bf16 v[152:155], v[156:159], a[156:159], v[152:155]
    v_fma_f32 v240, v201, v36, v240
    v_fma_f32 v241, v201, v38, v241
    s_waitcnt lgkmcnt(4)
    v_mfma_f32_32x32x16_bf16 v[112:127], a[128:131], a[84:87], v[112:127]
    s_add_u32 s92, s29, 16384
    buffer_load_dwordx4 a[68:71], v213, s[24:27], s92 offen sc1
    ds_read_b64_tr_b16 a[144:145], v187 offset:51200
    ds_read_b64_tr_b16 a[146:147], v187 offset:51712
    v_fma_f32 v240, -v202, v38, v240
    v_mfma_f32_32x32x16_bf16 v[128:143], a[132:135], a[84:87], v[128:143]
    ds_read_b64_tr_b16 a[148:149], v185 offset:52224
    ds_read_b64_tr_b16 a[150:151], v185 offset:52736
    v_fma_f32 v241, v202, v36, v241
    ds_write_b64 v144, v[240:241]
    s_waitcnt lgkmcnt(5)
    v_mfma_f32_32x32x16_bf16 v[96:111], a[136:139], a[88:91], v[96:111]
    s_add_u32 s92, s28, 16384
    buffer_load_dwordx4 a[72:75], v214, s[24:27], s92 offen sc1
    ds_read_b64_tr_b16 a[152:153], v186 offset:52224
    ds_read_b64_tr_b16 a[154:155], v186 offset:52736
    v_mfma_f32_16x16x32_bf16 v[152:155], v[156:159], a[136:139], v[152:155]
    v_mfma_f32_32x32x16_bf16 v[112:127], a[140:143], a[88:91], v[112:127]
    ds_read_b64_tr_b16 a[156:157], v187 offset:52224
    ds_read_b64_tr_b16 a[158:159], v187 offset:52736
    s_waitcnt lgkmcnt(5)
    v_mfma_f32_32x32x16_bf16 v[128:143], a[144:147], a[88:91], v[128:143]
    s_add_u32 s92, s29, 16384
    buffer_load_dwordx4 a[76:79], v214, s[24:27], s92 offen sc1
    s_waitcnt vmcnt(22)
    s_waitcnt lgkmcnt(4)
    s_barrier
    ds_read_b64_tr_b16 a[128:129], v181 offset:0
    ds_read_b64_tr_b16 a[130:131], v181 offset:512
    v_mfma_f32_32x32x16_bf16 v[96:111], a[148:151], a[92:95], v[96:111]
    ds_read_b64_tr_b16 a[132:133], v182 offset:0
    ds_read_b64_tr_b16 a[134:135], v182 offset:512
    ds_read_b64 v[40:41], v221 offset:0
    ds_read_b64 v[42:43], v221 offset:256
    ds_read_b64 v[44:45], v221 offset:512
    ds_read_b64 v[46:47], v221 offset:768
    v_mfma_f32_16x16x32_bf16 v[152:155], v[156:159], a[148:151], v[152:155]
    s_waitcnt lgkmcnt(8)
    v_mfma_f32_32x32x16_bf16 v[112:127], a[152:155], a[92:95], v[112:127]
    s_add_u32 m0, s82, 32768
    s_add_u32 s92, s56, 0
    buffer_load_dwordx4 v176, s[36:39], s92 offen offset:0 lds
    ds_read_b64_tr_b16 a[136:137], v183 offset:0
    ds_read_b64_tr_b16 a[138:139], v183 offset:512
    v_mfma_f32_32x32x16_bf16 v[128:143], a[156:159], a[92:95], v[128:143]
    ds_read_b64_tr_b16 a[140:141], v181 offset:1024
    ds_read_b64_tr_b16 a[142:143], v181 offset:1536
    s_waitcnt lgkmcnt(8)
    v_mfma_f32_32x32x16_bf16 v[96:111], a[128:131], a[96:99], v[96:111]
    buffer_load_dwordx4 v177, s[36:39], s92 offen offset:1024 lds
    ds_read_b64_tr_b16 a[144:145], v182 offset:1024
    ds_read_b64_tr_b16 a[146:147], v182 offset:1536
    s_waitcnt lgkmcnt(8)
    v_fma_f32 v42, v199, v40, v42
    v_fma_f32 v43, v199, v41, v43
    v_mfma_f32_16x16x32_bf16 v[152:155], v[156:159], a[128:131], v[152:155]
    v_fma_f32 v42, -v200, v41, v42
    v_fma_f32 v43, v200, v40, v43
    v_mfma_f32_32x32x16_bf16 v[112:127], a[132:135], a[96:99], v[112:127]
    ds_read_b64_tr_b16 a[148:149], v183 offset:1024
    ds_read_b64_tr_b16 a[150:151], v183 offset:1536
    s_waitcnt lgkmcnt(9)
    v_fma_f32 v44, v199, v42, v44
    v_fma_f32 v45, v199, v43, v45
    v_fma_f32 v44, -v200, v43, v44
    v_fma_f32 v45, v200, v42, v45
    s_waitcnt lgkmcnt(4)
    v_mfma_f32_32x32x16_bf16 v[128:143], a[136:139], a[96:99], v[128:143]
    buffer_load_dwordx4 v178, s[36:39], s92 offen offset:2048 lds
    ds_read_b64_tr_b16 a[152:153], v181 offset:2048
    ds_read_b64_tr_b16 a[154:155], v181 offset:2560
    v_fma_f32 v240, v199, v44, v46
    v_fma_f32 v241, v199, v45, v47
    v_mfma_f32_32x32x16_bf16 v[96:111], a[140:143], a[100:103], v[96:111]
    ds_read_b64_tr_b16 a[156:157], v182 offset:2048
    ds_read_b64_tr_b16 a[158:159], v182 offset:2560
    v_fma_f32 v240, -v200, v45, v240
    v_fma_f32 v241, v200, v44, v241
    v_mul_f32 v242, v206, v241
    v_mul_f32 v243, v206, v240
    v_mfma_f32_16x16x32_bf16 v[152:155], v[156:159], a[140:143], v[152:155]
    v_fma_f32 v240, v205, v240, -v242
    v_fma_f32 v241, v205, v241, v243
    s_waitcnt lgkmcnt(4)
    v_mfma_f32_32x32x16_bf16 v[112:127], a[144:147], a[100:103], v[112:127]
    buffer_load_dwordx4 v179, s[36:39], s92 offen offset:3072 lds
    ds_read_b64_tr_b16 a[128:129], v183 offset:2048
    ds_read_b64_tr_b16 a[130:131], v183 offset:2560
    v_fma_f32 v207, v203, v240, v207
    v_fma_f32 v208, v203, v241, v208
    v_mfma_f32_32x32x16_bf16 v[128:143], a[148:151], a[100:103], v[128:143]
    ds_read_b64_tr_b16 a[132:133], v181 offset:3072
    ds_read_b64_tr_b16 a[134:135], v181 offset:3584
    s_waitcnt vmcnt(9)
    v_fma_f32 v207, -v204, v241, v207
    v_fma_f32 v208, v204, v240, v208
    v_fma_f32 v0, v197, v207, v0
    s_waitcnt lgkmcnt(4)
    v_mfma_f32_32x32x16_bf16 v[96:111], a[152:155], a[104:107], v[96:111]
    s_add_u32 s92, s28, 16384
    buffer_load_dwordx4 a[80:83], v215, s[24:27], s92 offen sc1
    ds_read_b64_tr_b16 a[136:137], v182 offset:3072
    ds_read_b64_tr_b16 a[138:139], v182 offset:3584
    v_fma_f32 v16, v197, v208, v16
    v_mfma_f32_16x16x32_bf16 v[152:155], v[156:159], a[152:155], v[152:155]
    v_fma_f32 v0, -v198, v208, v0
    v_fma_f32 v16, v198, v207, v16
    v_mfma_f32_32x32x16_bf16 v[112:127], a[156:159], a[104:107], v[112:127]
    ds_read_b64_tr_b16 a[140:141], v183 offset:3072
    ds_read_b64_tr_b16 a[142:143], v183 offset:3584
    v_fma_f32 v1, v197, v0, v1
    v_fma_f32 v17, v197, v16, v17
    v_fma_f32 v1, -v198, v16, v1
    v_fma_f32 v17, v198, v0, v17
    s_waitcnt lgkmcnt(4)
    v_mfma_f32_32x32x16_bf16 v[128:143], a[128:131], a[104:107], v[128:143]
    s_add_u32 s92, s29, 16384
    buffer_load_dwordx4 a[84:87], v215, s[24:27], s92 offen sc1
    ds_read_b64_tr_b16 a[144:145], v181 offset:16384
    ds_read_b64_tr_b16 a[146:147], v181 offset:16896
    v_cvt_pk_bf16_f32 v224, v0, v1
    v_mfma_f32_32x32x16_bf16 v[96:111], a[132:135], a[108:111], v[96:111]
    ds_read_b64_tr_b16 a[148:149], v181 offset:17408
    ds_read_b64_tr_b16 a[150:151], v181 offset:17920
    v_cvt_pk_bf16_f32 v232, -v16, -v17
    v_fma_f32 v2, v197, v1, v2
    v_fma_f32 v18, v197, v17, v18
    v_fma_f32 v2, -v198, v17, v2
    v_mfma_f32_16x16x32_bf16 v[152:155], v[156:159], a[132:135], v[152:155]
    v_fma_f32 v18, v198, v1, v18
    v_fma_f32 v3, v197, v2, v3
    s_waitcnt lgkmcnt(4)
    v_mfma_f32_32x32x16_bf16 v[112:127], a[136:139], a[108:111], v[112:127]
    s_add_u32 s92, s28, 16384
    buffer_load_dwordx4 a[88:91], v219, s[24:27], s92 offen sc1
    ds_read_b64_tr_b16 a[152:153], v181 offset:18432
    ds_read_b64_tr_b16 a[154:155], v181 offset:18944
    v_fma_f32 v19, v197, v18, v19
    v_mfma_f32_32x32x16_bf16 v[128:143], a[140:143], a[108:111], v[128:143]
    ds_read_b64_tr_b16 a[156:157], v181 offset:19456
    ds_read_b64_tr_b16 a[158:159], v181 offset:19968
    v_fma_f32 v3, -v198, v18, v3
    v_fma_f32 v19, v198, v2, v19
    v_cvt_pk_bf16_f32 v225, v2, v3
    v_cvt_pk_bf16_f32 v233, -v18, -v19
    s_waitcnt lgkmcnt(4)
    v_mfma_f32_32x32x16_bf16 v[96:111], a[144:147], a[112:115], v[96:111]
    s_add_u32 s92, s29, 16384
    buffer_load_dwordx4 a[92:95], v219, s[24:27], s92 offen sc1
    ds_read_b64_tr_b16 a[128:129], v182 offset:16384
    ds_read_b64_tr_b16 a[130:131], v182 offset:16896
    v_fma_f32 v4, v197, v3, v4
    v_mfma_f32_16x16x32_bf16 v[152:155], v[156:159], a[144:147], v[152:155]
    v_fma_f32 v20, v197, v19, v20
    v_fma_f32 v4, -v198, v19, v4
    v_mfma_f32_32x32x16_bf16 v[96:111], a[148:151], a[116:119], v[96:111]
    ds_read_b64_tr_b16 a[132:133], v182 offset:17408
    ds_read_b64_tr_b16 a[134:135], v182 offset:17920
    v_fma_f32 v20, v198, v3, v20
    v_fma_f32 v5, v197, v4, v5
    v_fma_f32 v21, v197, v20, v21
    v_fma_f32 v5, -v198, v20, v5
    v_mfma_f32_16x16x32_bf16 v[152:155], v[156:159], a[148:151], v[152:155]
    v_fma_f32 v21, v198, v4, v21
    v_cvt_pk_bf16_f32 v226, v4, v5
    s_waitcnt lgkmcnt(4)
    v_mfma_f32_32x32x16_bf16 v[96:111], a[152:155], a[120:123], v[96:111]
    s_add_u32 s92, s93, 24576
    buffer_load_dwordx4 a[96:99], v213, s[24:27], s92 offen sc1
    ds_read_b64_tr_b16 a[136:137], v182 offset:18432
    ds_read_b64_tr_b16 a[138:139], v182 offset:18944
    v_cvt_pk_bf16_f32 v234, -v20, -v21
    v_mfma_f32_16x16x32_bf16 v[152:155], v[156:159], a[152:155], v[152:155]
    v_fma_f32 v6, v197, v5, v6
    v_fma_f32 v22, v197, v21, v22
    v_mfma_f32_32x32x16_bf16 v[96:111], a[156:159], a[124:127], v[96:111]
    ds_read_b64_tr_b16 a[140:141], v182 offset:19456
    ds_read_b64_tr_b16 a[142:143], v182 offset:19968
    v_fma_f32 v6, -v198, v21, v6
    v_fma_f32 v22, v198, v5, v22
    v_fma_f32 v7, v197, v6, v7
    v_fma_f32 v23, v197, v22, v23
    v_mfma_f32_16x16x32_bf16 v[152:155], v[156:159], a[156:159], v[152:155]
    v_fma_f32 v7, -v198, v22, v7
    v_fma_f32 v23, v198, v6, v23
    s_waitcnt lgkmcnt(4)
    v_mfma_f32_32x32x16_bf16 v[112:127], a[128:131], a[112:115], v[112:127]
    s_add_u32 s92, s94, 24576
    buffer_load_dwordx4 a[100:103], v213, s[24:27], s92 offen sc1
    ds_read_b64_tr_b16 a[144:145], v183 offset:16384
    ds_read_b64_tr_b16 a[146:147], v183 offset:16896
    v_cvt_pk_bf16_f32 v227, v6, v7
    v_mfma_f32_32x32x16_bf16 v[112:127], a[132:135], a[116:119], v[112:127]
    ds_read_b64_tr_b16 a[148:149], v183 offset:17408
    ds_read_b64_tr_b16 a[150:151], v183 offset:17920
    v_cvt_pk_bf16_f32 v235, -v22, -v23
    v_fma_f32 v8, v197, v7, v8
    v_fma_f32 v24, v197, v23, v24
    v_fma_f32 v8, -v198, v23, v8
    s_waitcnt lgkmcnt(4)
    v_mfma_f32_32x32x16_bf16 v[112:127], a[136:139], a[120:123], v[112:127]
    s_add_u32 s92, s93, 24576
    buffer_load_dwordx4 a[104:107], v214, s[24:27], s92 offen sc1
    ds_read_b64_tr_b16 a[152:153], v183 offset:18432
    ds_read_b64_tr_b16 a[154:155], v183 offset:18944
    v_fma_f32 v24, v198, v7, v24
    v_mfma_f32_32x32x16_bf16 v[112:127], a[140:143], a[124:127], v[112:127]
    ds_read_b64_tr_b16 a[156:157], v183 offset:19456
    ds_read_b64_tr_b16 a[158:159], v183 offset:19968
    v_fma_f32 v9, v197, v8, v9
    v_fma_f32 v25, v197, v24, v25
    v_fma_f32 v9, -v198, v24, v9
    v_fma_f32 v25, v198, v8, v25
    s_waitcnt lgkmcnt(4)
    v_mfma_f32_32x32x16_bf16 v[128:143], a[144:147], a[112:115], v[128:143]
    s_add_u32 s92, s94, 24576
    buffer_load_dwordx4 a[108:111], v214, s[24:27], s92 offen sc1
    v_cvt_pk_bf16_f32 v228, v8, v9
    v_cvt_pk_bf16_f32 v236, -v24, -v25
    v_fma_f32 v10, v197, v9, v10
    v_mfma_f32_32x32x16_bf16 v[128:143], a[148:151], a[116:119], v[128:143]
    v_fma_f32 v26, v197, v25, v26
    v_fma_f32 v10, -v198, v25, v10
    v_fma_f32 v26, v198, v9, v26
    v_fma_f32 v11, v197, v10, v11
    v_fma_f32 v27, v197, v26, v27
    v_fma_f32 v11, -v198, v26, v11
    s_waitcnt lgkmcnt(0)
    v_mfma_f32_32x32x16_bf16 v[128:143], a[152:155], a[120:123], v[128:143]
    s_add_u32 m0, s82, 49152
    s_add_u32 s92, s57, 0
    buffer_load_dwordx4 v176, s[36:39], s92 offen offset:0 lds
    v_fma_f32 v27, v198, v10, v27
    v_cvt_pk_bf16_f32 v229, v10, v11
    v_mfma_f32_32x32x16_bf16 v[128:143], a[156:159], a[124:127], v[128:143]
    v_cvt_pk_bf16_f32 v237, -v26, -v27
    v_fma_f32 v12, v197, v11, v12
    v_fma_f32 v28, v197, v27, v28
    v_fma_f32 v12, -v198, v27, v12
    v_fma_f32 v28, v198, v11, v28
    v_fma_f32 v13, v197, v12, v13
Lmark2:
    s_barrier
    buffer_store_dword v247, v254, s[24:27], s50 offen sc1
    v_fma_f32 v29, v197, v28, v29
    v_fma_f32 v13, -v198, v28, v13
    v_fma_f32 v29, v198, v12, v29
    v_cvt_pk_bf16_f32 v230, v12, v13
    v_cvt_pk_bf16_f32 v238, -v28, -v29
    v_fma_f32 v14, v197, v13, v14
    v_fma_f32 v30, v197, v29, v30
    v_fma_f32 v14, -v198, v29, v14
    v_fma_f32 v30, v198, v13, v30
    v_fma_f32 v15, v197, v14, v15
    v_fma_f32 v31, v197, v30, v31
    v_fma_f32 v15, -v198, v30, v15
    v_fma_f32 v31, v198, v14, v31
    v_cvt_pk_bf16_f32 v231, v14, v15
    v_cvt_pk_bf16_f32 v239, -v30, -v31
    buffer_load_dwordx4 v177, s[36:39], s92 offen offset:1024 lds
    ds_write_b128 v216, v[224:227]
    ds_write_b128 v216, v[228:231] offset:16
    ds_write_b128 v216, v[232:235] offset:2560
    ds_write_b128 v216, v[236:239] offset:2576
    s_waitcnt lgkmcnt(0)
    ds_read_b64_tr_b16 v[32:33], v217 offset:0
    ds_read_b64_tr_b16 v[34:35], v217 offset:320
    ds_read_b64_tr_b16 v[36:37], v217 offset:1280
    ds_read_b64_tr_b16 v[38:39], v217 offset:1600
    ds_read_b64_tr_b16 v[40:41], v217 offset:2560
    ds_read_b64_tr_b16 v[42:43], v217 offset:2880
    ds_read_b64_tr_b16 v[44:45], v217 offset:3840
    ds_read_b64_tr_b16 v[46:47], v217 offset:4160
    s_waitcnt lgkmcnt(6)
    buffer_store_dwordx4 v[32:35], v194, s[24:27], s84 offen offset:0 sc1
    s_waitcnt lgkmcnt(4)
    buffer_store_dwordx4 v[36:39], v194, s[24:27], s84 offen offset:1024 sc1
    s_waitcnt lgkmcnt(2)
    buffer_store_dwordx4 v[40:43], v194, s[24:27], s84 offen offset:2048 sc1
    buffer_load_dwordx4 v178, s[36:39], s92 offen offset:2048 lds
    s_waitcnt lgkmcnt(0)
    buffer_store_dwordx4 v[44:47], v194, s[24:27], s84 offen offset:3072 sc1
    ds_write_b32 v218, v152 offset:1024
    ds_write_b32 v218, v152 offset:1408
    v_cvt_pk_bf16_f32 v249, v152, v152
    v_and_b32 v249, 0xffff0000, v249
    v_sub_f32 v250, v152, v249
    v_cvt_pk_bf16_f32 v164, v249, v250
    s_nop 1
    v_mfma_f32_32x32x16_bf16 v[96:111], v[164:167], v[160:163], v[96:111]
    s_nop 11
    v_mul_f32 v96, v195, v96
    v_mul_f32 v97, v195, v97
    v_mul_f32 v98, v195, v98
    v_mul_f32 v99, v195, v99
    v_exp_f32 v96, v96
    v_exp_f32 v97, v97
    buffer_load_dwordx4 v179, s[36:39], s92 offen offset:3072 lds
    v_exp_f32 v98, v98
    v_exp_f32 v99, v99
    v_fma_f32 v96, v96, v196, v196
    v_fma_f32 v97, v97, v196, v196
    v_fma_f32 v98, v98, v196, v196
    v_fma_f32 v99, v99, v196, v196
    v_rcp_f32 v96, v96
    v_rcp_f32 v97, v97
    v_rcp_f32 v98, v98
    v_rcp_f32 v99, v99
    s_add_u32 m0, s82, 65536
    s_add_u32 s92, s56, 0
    buffer_load_dwordx4 v176, s[40:43], s92 offen offset:0 lds
    v_mul_f32 v104, v104, v96
    v_mul_f32 v105, v105, v97
    v_mul_f32 v106, v106, v98
    v_mul_f32 v107, v107, v99
    v_mul_f32 v100, v195, v100
    v_mul_f32 v101, v195, v101
    v_mul_f32 v102, v195, v102
    v_mul_f32 v103, v195, v103
    v_exp_f32 v100, v100
    v_exp_f32 v101, v101
    v_exp_f32 v102, v102
    v_exp_f32 v103, v103
    buffer_load_dwordx4 v177, s[40:43], s92 offen offset:1024 lds
    v_fma_f32 v100, v100, v196, v196
    v_fma_f32 v101, v101, v196, v196
    v_fma_f32 v102, v102, v196, v196
    v_fma_f32 v103, v103, v196, v196
    v_rcp_f32 v100, v100
    v_rcp_f32 v101, v101
    v_rcp_f32 v102, v102
    v_rcp_f32 v103, v103
    v_mul_f32 v108, v108, v100
    v_mul_f32 v109, v109, v101
    v_mul_f32 v110, v110, v102
    v_mul_f32 v111, v111, v103
    buffer_load_dwordx4 v178, s[40:43], s92 offen offset:2048 lds
    v_cvt_pk_bf16_f32 v96, v104, v105
    v_cvt_pk_bf16_f32 v97, v106, v107
    v_cvt_pk_bf16_f32 v98, v108, v109
    v_cvt_pk_bf16_f32 v99, v110, v111
    buffer_store_dwordx4 v[96:99], v194, s[24:27], s89 offen sc1
    s_waitcnt lgkmcnt(0)
    s_barrier
    ds_read_b32 v251, v218 offset:1152
    s_waitcnt lgkmcnt(0)
    v_cvt_pk_bf16_f32 v249, v251, v251
    v_and_b32 v249, 0xffff0000, v249
    v_sub_f32 v250, v251, v249
    v_cvt_pk_bf16_f32 v168, v249, v250
    s_nop 1
    v_mfma_f32_32x32x16_bf16 v[112:127], v[168:171], v[160:163], v[112:127]
    s_nop 11
    v_mul_f32 v112, v195, v112
    v_mul_f32 v113, v195, v113
    buffer_load_dwordx4 v179, s[40:43], s92 offen offset:3072 lds
    v_mul_f32 v114, v195, v114
    v_mul_f32 v115, v195, v115
    v_exp_f32 v112, v112
    v_exp_f32 v113, v113
    v_exp_f32 v114, v114
    v_exp_f32 v115, v115
    v_fma_f32 v112, v112, v196, v196
    v_fma_f32 v113, v113, v196, v196
    v_fma_f32 v114, v114, v196, v196
    v_fma_f32 v115, v115, v196, v196
    v_rcp_f32 v112, v112
    s_add_u32 m0, s82, 81920
    s_add_u32 s92, s57, 0
    buffer_load_dwordx4 v176, s[40:43], s92 offen offset:0 lds
    v_rcp_f32 v113, v113
    v_rcp_f32 v114, v114
    v_rcp_f32 v115, v115
    v_mul_f32 v120, v120, v112
    v_mul_f32 v121, v121, v113
    v_mul_f32 v122, v122, v114
    v_mul_f32 v123, v123, v115
    v_mul_f32 v116, v195, v116
    v_mul_f32 v117, v195, v117
    v_mul_f32 v118, v195, v118
    v_mul_f32 v119, v195, v119
    v_exp_f32 v116, v116
    buffer_load_dwordx4 v177, s[40:43], s92 offen offset:1024 lds
    v_exp_f32 v117, v117
    v_exp_f32 v118, v118
    v_exp_f32 v119, v119
    v_fma_f32 v116, v116, v196, v196
    v_fma_f32 v117, v117, v196, v196
    v_fma_f32 v118, v118, v196, v196
    v_fma_f32 v119, v119, v196, v196
    v_rcp_f32 v116, v116
    v_rcp_f32 v117, v117
    v_rcp_f32 v118, v118
    buffer_load_dwordx4 v178, s[40:43], s92 offen offset:2048 lds
    v_rcp_f32 v119, v119
    v_mul_f32 v124, v124, v116
    v_mul_f32 v125, v125, v117
    v_mul_f32 v126, v126, v118
    v_mul_f32 v127, v127, v119
    v_cvt_pk_bf16_f32 v112, v120, v121
    v_cvt_pk_bf16_f32 v113, v122, v123
    v_cvt_pk_bf16_f32 v114, v124, v125
    v_cvt_pk_bf16_f32 v115, v126, v127
    buffer_store_dwordx4 v[112:115], v194, s[24:27], s90 offen sc1
    ds_read_b32 v251, v218 offset:1280
    s_waitcnt lgkmcnt(0)
    v_cvt_pk_bf16_f32 v249, v251, v251
    v_and_b32 v249, 0xffff0000, v249
    v_sub_f32 v250, v251, v249
    v_cvt_pk_bf16_f32 v164, v249, v250
    buffer_load_dwordx4 v179, s[40:43], s92 offen offset:3072 lds
    s_nop 0
    v_mfma_f32_32x32x16_bf16 v[128:143], v[164:167], v[160:163], v[128:143]
    s_nop 11
    v_mul_f32 v128, v195, v128
    v_mul_f32 v129, v195, v129
    v_mul_f32 v130, v195, v130
    v_mul_f32 v131, v195, v131
    v_exp_f32 v128, v128
    v_exp_f32 v129, v129
    v_exp_f32 v130, v130
    v_exp_f32 v131, v131
    v_fma_f32 v128, v128, v196, v196
    v_fma_f32 v129, v129, v196, v196
    s_add_u32 m0, s82, 98304
    s_add_u32 s92, s56, 128
    buffer_load_dwordx4 v176, s[36:39], s92 offen offset:0 lds
    v_fma_f32 v130, v130, v196, v196
    v_fma_f32 v131, v131, v196, v196
    v_rcp_f32 v128, v128
    v_rcp_f32 v129, v129
    v_rcp_f32 v130, v130
    v_rcp_f32 v131, v131
    v_mul_f32 v136, v136, v128
    v_mul_f32 v137, v137, v129
    v_mul_f32 v138, v138, v130
    v_mul_f32 v139, v139, v131
    v_mul_f32 v132, v195, v132
    v_mul_f32 v133, v195, v133
    buffer_load_dwordx4 v177, s[36:39], s92 offen offset:1024 lds
    v_mul_f32 v134, v195, v134
    v_mul_f32 v135, v195, v135
    v_exp_f32 v132, v132
    v_exp_f32 v133, v133
    v_exp_f32 v134, v134
    v_exp_f32 v135, v135
    v_fma_f32 v132, v132, v196, v196
    v_fma_f32 v133, v133, v196, v196
    v_fma_f32 v134, v134, v196, v196
    v_fma_f32 v135, v135, v196, v196
    v_rcp_f32 v132, v132
    buffer_load_dwordx4 v178, s[36:39], s92 offen offset:2048 lds
    v_rcp_f32 v133, v133
    v_rcp_f32 v134, v134
    v_rcp_f32 v135, v135
    v_mul_f32 v140, v140, v132
    v_mul_f32 v141, v141, v133
    v_mul_f32 v142, v142, v134
    v_mul_f32 v143, v143, v135
    v_cvt_pk_bf16_f32 v128, v136, v137
    v_cvt_pk_bf16_f32 v129, v138, v139
    v_cvt_pk_bf16_f32 v130, v140, v141
    v_cvt_pk_bf16_f32 v131, v142, v143
    buffer_store_dwordx4 v[128:131], v194, s[24:27], s91 offen sc1
    buffer_load_dwordx4 v179, s[36:39], s92 offen offset:3072 lds
    buffer_load_dword v246, v244, s[24:27], s3 offen sc1
    s_add_u32 m0, s82, 114688
    s_add_u32 s92, s57, 128
    buffer_load_dwordx4 v176, s[36:39], s92 offen offset:0 lds
    buffer_load_dwordx4 v177, s[36:39], s92 offen offset:1024 lds
    buffer_load_dwordx4 v178, s[36:39], s92 offen offset:2048 lds
    buffer_load_dwordx4 v179, s[36:39], s92 offen offset:3072 lds
    s_add_u32 m0, s82, 0
    s_add_u32 s92, s56, 128
    buffer_load_dwordx4 v176, s[40:43], s92 offen offset:0 lds
    buffer_load_dwordx4 v177, s[40:43], s92 offen offset:1024 lds
    buffer_load_dwordx4 v178, s[40:43], s92 offen offset:2048 lds
    buffer_load_dwordx4 v179, s[40:43], s92 offen offset:3072 lds
    s_add_u32 m0, s82, 16384
    s_add_u32 s92, s57, 128
    buffer_load_dwordx4 v176, s[40:43], s92 offen offset:0 lds
    buffer_load_dwordx4 v177, s[40:43], s92 offen offset:1024 lds
    buffer_load_dwordx4 v178, s[40:43], s92 offen offset:2048 lds
    buffer_load_dwordx4 v179, s[40:43], s92 offen offset:3072 lds
    s_add_u32 s92, s93, 24576
    buffer_load_dwordx4 a[112:115], v215, s[24:27], s92 offen sc1
    s_add_u32 s92, s94, 24576
    buffer_load_dwordx4 a[116:119], v215, s[24:27], s92 offen sc1
    s_add_u32 s92, s93, 24576
    buffer_load_dwordx4 a[120:123], v219, s[24:27], s92 offen sc1
    s_add_u32 s92, s94, 24576
    buffer_load_dwordx4 a[124:127], v219, s[24:27], s92 offen sc1
    s_waitcnt vmcnt(16)
    v_cmp_ne_u32 vcc, s99, v246
    s_nop 3
    s_cbranch_vccnz Lretry3
Lback3:
    s_add_u32 s3, s3, 8192
    buffer_load_dwordx4 v[48:51], v213, s[24:27], s54 offen sc1
    buffer_load_dwordx4 v[52:55], v213, s[24:27], s55 offen sc1
    buffer_load_dwordx4 v[56:59], v214, s[24:27], s54 offen sc1
    buffer_load_dwordx4 v[60:63], v214, s[24:27], s55 offen sc1
    buffer_load_dwordx4 v[64:67], v215, s[24:27], s54 offen sc1
    buffer_load_dwordx4 v[68:71], v215, s[24:27], s55 offen sc1
    buffer_load_dwordx4 v[72:75], v219, s[24:27], s54 offen sc1
    buffer_load_dwordx4 v[76:79], v219, s[24:27], s55 offen sc1
    buffer_load_dwordx4 v[80:83], v213, s[24:27], s30 offen sc1
    buffer_load_dwordx4 v[84:87], v213, s[24:27], s31 offen sc1
    s_barrier
    buffer_store_dword v247, v254, s[24:27], s51 offen sc1
    buffer_store_dword v247, v254, s[24:27], s66 offen sc1
    buffer_load_dwordx4 v[88:91], v214, s[24:27], s30 offen sc1
    s_waitcnt vmcnt(12)
    v_mfma_f32_32x32x16_bf16 v[96:111], a[160:163], v[48:51], 0
    buffer_load_dwordx4 v[92:95], v214, s[24:27], s31 offen sc1
    v_mfma_f32_32x32x16_bf16 v[112:127], a[164:167], v[48:51], 0
    v_lshrrev_b32 v225, 3, v223
    v_and_b32 v226, 7, v223
    v_lshrrev_b32 v227, 2, v225
    v_and_b32 v228, 3, v225
    v_lshl_add_u32 v227, v227, 4, v228
    v_lshlrev_b32 v184, 3, v226
    v_lshl_add_u32 v181, v227, 10, v184
    v_lshlrev_b32 v182, 1, v181
    v_lshlrev_b32 v183, 5, v225
    v_add_u32 v184, s48, v184
    global_load_dwordx2 v[16:17], v184, s[20:21]
    s_waitcnt vmcnt(13)
    v_mfma_f32_32x32x16_bf16 v[144:159], a[164:167], v[52:55], 0
    buffer_load_dwordx4 v[8:11], v183, s[24:27], s61 offen offset:0 sc1
    v_mfma_f32_32x32x16_bf16 v[128:143], a[160:163], v[52:55], 0
    buffer_load_dwordx4 v[12:15], v183, s[24:27], s61 offen offset:16 sc1
    s_add_u32 s92, s60, 0
    buffer_load_dwordx2 v[0:1], v181, s[4:7], s92 offen
    s_add_u32 s92, s60, 4096
    buffer_load_dwordx2 v[2:3], v181, s[4:7], s92 offen
    s_add_u32 s92, s60, 8192
    buffer_load_dwordx2 v[4:5], v181, s[4:7], s92 offen
    s_add_u32 s92, s60, 12288
    buffer_load_dwordx2 v[6:7], v181, s[4:7], s92 offen
    buffer_load_dwordx4 v[48:51], v215, s[24:27], s30 offen sc1
    s_waitcnt vmcnt(19)
    v_mfma_f32_32x32x16_bf16 v[96:111], a[168:171], v[56:59], v[96:111]
    buffer_load_dwordx4 v[52:55], v215, s[24:27], s31 offen sc1
    v_mfma_f32_32x32x16_bf16 v[112:127], a[172:175], v[56:59], v[112:127]
    s_waitcnt vmcnt(19)
    v_mfma_f32_32x32x16_bf16 v[144:159], a[172:175], v[60:63], v[144:159]
    v_mfma_f32_32x32x16_bf16 v[128:143], a[168:171], v[60:63], v[128:143]
    buffer_load_dwordx4 v[56:59], v219, s[24:27], s30 offen sc1
    s_waitcnt vmcnt(19)
    v_mfma_f32_32x32x16_bf16 v[96:111], a[176:179], v[64:67], v[96:111]
    buffer_load_dwordx4 v[60:63], v219, s[24:27], s31 offen sc1
    v_mfma_f32_32x32x16_bf16 v[112:127], a[180:183], v[64:67], v[112:127]
    s_waitcnt vmcnt(19)
    v_mfma_f32_32x32x16_bf16 v[144:159], a[180:183], v[68:71], v[144:159]
    v_mfma_f32_32x32x16_bf16 v[128:143], a[176:179], v[68:71], v[128:143]
    s_add_u32 s92, s54, 8192
    buffer_load_dwordx4 v[64:67], v213, s[24:27], s92 offen sc1
    s_waitcnt vmcnt(19)
    v_mfma_f32_32x32x16_bf16 v[96:111], a[184:187], v[72:75], v[96:111]
    s_add_u32 s92, s55, 8192
    buffer_load_dwordx4 v[68:71], v213, s[24:27], s92 offen sc1
    v_mfma_f32_32x32x16_bf16 v[112:127], a[188:191], v[72:75], v[112:127]
    s_waitcnt vmcnt(19)
    v_mfma_f32_32x32x16_bf16 v[144:159], a[188:191], v[76:79], v[144:159]
    v_mfma_f32_32x32x16_bf16 v[128:143], a[184:187], v[76:79], v[128:143]
    s_add_u32 s92, s54, 8192
    buffer_load_dwordx4 v[72:75], v214, s[24:27], s92 offen sc1
    s_waitcnt vmcnt(19)
    v_mfma_f32_32x32x16_bf16 v[96:111], a[192:195], v[80:83], v[96:111]
    s_add_u32 s92, s55, 8192
    buffer_load_dwordx4 v[76:79], v214, s[24:27], s92 offen sc1
    v_mfma_f32_32x32x16_bf16 v[112:127], a[196:199], v[80:83], v[112:127]
    s_waitcnt vmcnt(19)
    v_mfma_f32_32x32x16_bf16 v[144:159], a[196:199], v[84:87], v[144:159]
    v_mfma_f32_32x32x16_bf16 v[128:143], a[192:195], v[84:87], v[128:143]
    s_add_u32 s92, s54, 8192
    buffer_load_dwordx4 v[80:83], v215, s[24:27], s92 offen sc1
    s_waitcnt vmcnt(17)
    v_mfma_f32_32x32x16_bf16 v[96:111], a[200:203], v[88:91], v[96:111]
    s_add_u32 s92, s55, 8192
    buffer_load_dwordx4 v[84:87], v215, s[24:27], s92 offen sc1
    v_mfma_f32_32x32x16_bf16 v[112:127], a[204:207], v[88:91], v[112:127]
    s_waitcnt vmcnt(17)
    v_mfma_f32_32x32x16_bf16 v[144:159], a[204:207], v[92:95], v[144:159]
    v_mfma_f32_32x32x16_bf16 v[128:143], a[200:203], v[92:95], v[128:143]
    buffer_load_dword v246, v244, s[24:27], s3 offen sc1
    s_add_u32 s92, s54, 8192
    buffer_load_dwordx4 v[88:91], v219, s[24:27], s92 offen sc1
    s_waitcnt vmcnt(11)
    v_mfma_f32_32x32x16_bf16 v[96:111], a[208:211], v[48:51], v[96:111]
    s_add_u32 s92, s55, 8192
    buffer_load_dwordx4 v[92:95], v219, s[24:27], s92 offen sc1
    v_mfma_f32_32x32x16_bf16 v[112:127], a[212:215], v[48:51], v[112:127]
    s_waitcnt vmcnt(11)
    v_mfma_f32_32x32x16_bf16 v[144:159], a[212:215], v[52:55], v[144:159]
    v_mfma_f32_32x32x16_bf16 v[128:143], a[208:211], v[52:55], v[128:143]
    s_add_u32 s92, s30, 8192
    buffer_load_dwordx4 v[48:51], v213, s[24:27], s92 offen sc1
    s_waitcnt vmcnt(11)
    v_mfma_f32_32x32x16_bf16 v[96:111], a[216:219], v[56:59], v[96:111]
    s_add_u32 s92, s31, 8192
    buffer_load_dwordx4 v[52:55], v213, s[24:27], s92 offen sc1
    v_mfma_f32_32x32x16_bf16 v[112:127], a[220:223], v[56:59], v[112:127]
    s_waitcnt vmcnt(11)
    v_mfma_f32_32x32x16_bf16 v[144:159], a[220:223], v[60:63], v[144:159]
    v_mfma_f32_32x32x16_bf16 v[128:143], a[216:219], v[60:63], v[128:143]
    s_add_u32 s92, s30, 8192
    buffer_load_dwordx4 v[56:59], v214, s[24:27], s92 offen sc1
    s_waitcnt vmcnt(11)
    v_mfma_f32_32x32x16_bf16 v[96:111], a[224:227], v[64:67], v[96:111]
    s_add_u32 s92, s31, 8192
    buffer_load_dwordx4 v[60:63], v214, s[24:27], s92 offen sc1
    v_mfma_f32_32x32x16_bf16 v[112:127], a[228:231], v[64:67], v[112:127]
    s_waitcnt vmcnt(11)
    v_mfma_f32_32x32x16_bf16 v[144:159], a[228:231], v[68:71], v[144:159]
    v_mfma_f32_32x32x16_bf16 v[128:143], a[224:227], v[68:71], v[128:143]
    s_add_u32 s92, s30, 8192
    buffer_load_dwordx4 v[64:67], v215, s[24:27], s92 offen sc1
    s_waitcnt vmcnt(11)
    v_mfma_f32_32x32x16_bf16 v[96:111], a[232:235], v[72:75], v[96:111]
    s_add_u32 s92, s31, 8192
    buffer_load_dwordx4 v[68:71], v215, s[24:27], s92 offen sc1
    v_mfma_f32_32x32x16_bf16 v[112:127], a[236:239], v[72:75], v[112:127]
    s_waitcnt vmcnt(11)
    v_mfma_f32_32x32x16_bf16 v[144:159], a[236:239], v[76:79], v[144:159]
    v_mfma_f32_32x32x16_bf16 v[128:143], a[232:235], v[76:79], v[128:143]
    s_add_u32 s92, s30, 8192
    buffer_load_dwordx4 v[72:75], v219, s[24:27], s92 offen sc1
    s_waitcnt vmcnt(11)
    v_mfma_f32_32x32x16_bf16 v[96:111], a[240:243], v[80:83], v[96:111]
    s_add_u32 s92, s31, 8192
    buffer_load_dwordx4 v[76:79], v219, s[24:27], s92 offen sc1
    v_mfma_f32_32x32x16_bf16 v[112:127], a[244:247], v[80:83], v[112:127]
    s_waitcnt vmcnt(11)
    v_mfma_f32_32x32x16_bf16 v[144:159], a[244:247], v[84:87], v[144:159]
    v_mfma_f32_32x32x16_bf16 v[128:143], a[240:243], v[84:87], v[128:143]
    s_waitcnt vmcnt(10)
    v_cmp_ne_u32 vcc, s99, v246
    s_nop 3
    s_cbranch_vccnz Lretry4
Lback4:
    s_add_u32 s92, s54, 16384
    buffer_load_dwordx4 v[80:83], v213, s[24:27], s92 offen sc1
    s_waitcnt vmcnt(10)
    v_mfma_f32_32x32x16_bf16 v[96:111], a[248:251], v[88:91], v[96:111]
    s_add_u32 s92, s55, 16384
    buffer_load_dwordx4 v[84:87], v213, s[24:27], s92 offen sc1
    v_mfma_f32_32x32x16_bf16 v[112:127], a[252:255], v[88:91], v[112:127]
    s_waitcnt vmcnt(10)
    v_mfma_f32_32x32x16_bf16 v[144:159], a[252:255], v[92:95], v[144:159]
    v_mfma_f32_32x32x16_bf16 v[128:143], a[248:251], v[92:95], v[128:143]
    s_add_u32 s92, s54, 16384
    buffer_load_dwordx4 v[88:91], v214, s[24:27], s92 offen sc1
    s_waitcnt vmcnt(10)
    v_mfma_f32_32x32x16_bf16 v[96:111], a[0:3], v[48:51], v[96:111]
    s_add_u32 s92, s55, 16384
    buffer_load_dwordx4 v[92:95], v214, s[24:27], s92 offen sc1
    v_xor_b32 v229, v225, v226
    v_lshlrev_b32 v229, 4, v229
    v_lshl_add_u32 v229, v225, 7, v229
    v_mfma_f32_32x32x16_bf16 v[112:127], a[4:7], v[48:51], v[112:127]
    s_xor_b32 s67, s82, 0
    v_add_u32 v236, s67, v229
    s_xor_b32 s67, s82, 4096
    s_waitcnt vmcnt(10)
    v_mfma_f32_32x32x16_bf16 v[144:159], a[4:7], v[52:55], v[144:159]
    v_add_u32 v237, s67, v229
    s_xor_b32 s67, s82, 8192
    v_add_u32 v238, s67, v229
    v_mfma_f32_32x32x16_bf16 v[128:143], a[0:3], v[52:55], v[128:143]
    s_xor_b32 s67, s82, 12288
    v_add_u32 v239, s67, v229
    v_lshrrev_b32 v230, 5, v223
    s_add_u32 s92, s54, 16384
    buffer_load_dwordx4 v[48:51], v215, s[24:27], s92 offen sc1
    s_waitcnt vmcnt(10)
    v_mfma_f32_32x32x16_bf16 v[96:111], a[8:11], v[56:59], v[96:111]
    s_add_u32 s92, s55, 16384
    buffer_load_dwordx4 v[52:55], v215, s[24:27], s92 offen sc1
    v_xor_b32 v230, v230, v226
    v_lshlrev_b32 v230, 4, v230
    v_lshl_add_u32 v231, v222, 7, s82
    v_mfma_f32_32x32x16_bf16 v[112:127], a[12:15], v[56:59], v[112:127]
    v_xor_b32 v185, 0, v230
    v_add_u32 v185, v231, v185
    v_xor_b32 v186, 32, v230
    s_waitcnt vmcnt(10)
    v_mfma_f32_32x32x16_bf16 v[144:159], a[12:15], v[60:63], v[144:159]
    v_add_u32 v186, v231, v186
    v_xor_b32 v187, 64, v230
    v_add_u32 v187, v231, v187
    v_mfma_f32_32x32x16_bf16 v[128:143], a[8:11], v[60:63], v[128:143]
    v_xor_b32 v188, 96, v230
    v_add_u32 v188, v231, v188
    v_and_b32 v19, 0xffff0000, v17
    s_add_u32 s92, s54, 16384
    buffer_load_dwordx4 v[56:59], v219, s[24:27], s92 offen sc1
    s_waitcnt vmcnt(10)
    v_mfma_f32_32x32x16_bf16 v[96:111], a[16:19], v[64:67], v[96:111]
    s_add_u32 s92, s55, 16384
    buffer_load_dwordx4 v[60:63], v219, s[24:27], s92 offen sc1
    v_lshlrev_b32 v18, 16, v17
    v_and_b32 v17, 0xffff0000, v16
    v_lshlrev_b32 v16, 16, v16
    v_mfma_f32_32x32x16_bf16 v[112:127], a[20:23], v[64:67], v[112:127]
    v_rcp_f32 v232, v9
    v_lshlrev_b32 v20, 16, v0
    v_sub_f32 v233, v20, v8
    s_waitcnt vmcnt(10)
    v_mfma_f32_32x32x16_bf16 v[144:159], a[20:23], v[68:71], v[144:159]
    ds_read_b128 a[128:131], v172 offset:32768
    ds_read_b128 a[132:135], v172 offset:49152
    v_cvt_pk_bf16_f32 v233, v233, v233
    v_and_b32 v233, 0xffff0000, v233
    v_mul_f32 v234, v233, v232
    v_mfma_f32_32x32x16_bf16 v[128:143], a[16:19], v[68:71], v[128:143]
    v_fma_f32 v233, -v234, v9, v233
    v_fma_f32 v233, v233, v232, v234
    v_cvt_pk_bf16_f32 v233, v233, v233
    s_add_u32 s92, s30, 16384
    buffer_load_dwordx4 v[64:67], v213, s[24:27], s92 offen sc1
    s_waitcnt vmcnt(10)
    v_mfma_f32_32x32x16_bf16 v[96:111], a[24:27], v[72:75], v[96:111]
    s_add_u32 s92, s31, 16384
    buffer_load_dwordx4 v[68:71], v213, s[24:27], s92 offen sc1
    v_and_b32 v233, 0xffff0000, v233
    v_mul_f32 v233, v233, v16
    v_cvt_pk_bf16_f32 v233, v233, v233
    v_mfma_f32_32x32x16_bf16 v[112:127], a[28:31], v[72:75], v[112:127]
    v_and_b32 v233, 0xffff0000, v233
    v_add_f32 v20, v233, v20
    v_and_b32 v21, 0xffff0000, v0
    s_waitcnt vmcnt(10)
    v_mfma_f32_32x32x16_bf16 v[144:159], a[28:31], v[76:79], v[144:159]
    ds_read_b128 a[136:139], v173 offset:32768
    ds_read_b128 a[140:143], v173 offset:49152
    v_sub_f32 v233, v21, v8
    v_cvt_pk_bf16_f32 v233, v233, v233
    v_and_b32 v233, 0xffff0000, v233
    v_mfma_f32_32x32x16_bf16 v[128:143], a[24:27], v[76:79], v[128:143]
    v_mul_f32 v234, v233, v232
    v_fma_f32 v233, -v234, v9, v233
    v_fma_f32 v233, v233, v232, v234
    s_add_u32 s92, s30, 16384
    buffer_load_dwordx4 v[72:75], v214, s[24:27], s92 offen sc1
    s_waitcnt vmcnt(10) lgkmcnt(3)
    v_mfma_f32_32x32x16_bf16 v[96:111], a[128:131], v[80:83], v[96:111]
    s_add_u32 s92, s31, 16384
    buffer_load_dwordx4 v[76:79], v214, s[24:27], s92 offen sc1
    v_cvt_pk_bf16_f32 v233, v233, v233
    v_and_b32 v233, 0xffff0000, v233
    v_mul_f32 v233, v233, v17
    s_waitcnt lgkmcnt(2)
    v_mfma_f32_32x32x16_bf16 v[112:127], a[132:135], v[80:83], v[112:127]
    v_cvt_pk_bf16_f32 v233, v233, v233
    v_and_b32 v233, 0xffff0000, v233
    v_add_f32 v21, v233, v21
    s_waitcnt vmcnt(10)
    v_mfma_f32_32x32x16_bf16 v[144:159], a[132:135], v[84:87], v[144:159]
    ds_read_b128 a[144:147], v180 offset:0
    ds_read_b128 a[148:151], v180 offset:16384
    v_lshlrev_b32 v22, 16, v1
    v_sub_f32 v233, v22, v8
    v_cvt_pk_bf16_f32 v233, v233, v233
    v_mfma_f32_32x32x16_bf16 v[128:143], a[128:131], v[84:87], v[128:143]
    v_and_b32 v233, 0xffff0000, v233
    v_mul_f32 v234, v233, v232
    v_fma_f32 v233, -v234, v9, v233
    s_add_u32 s92, s30, 16384
    buffer_load_dwordx4 v[80:83], v215, s[24:27], s92 offen sc1
    s_waitcnt vmcnt(10) lgkmcnt(3)
    v_mfma_f32_32x32x16_bf16 v[96:111], a[136:139], v[88:91], v[96:111]
    s_add_u32 s92, s31, 16384
    buffer_load_dwordx4 v[84:87], v215, s[24:27], s92 offen sc1
    v_fma_f32 v233, v233, v232, v234
    v_cvt_pk_bf16_f32 v233, v233, v233
    v_and_b32 v233, 0xffff0000, v233
    s_waitcnt lgkmcnt(2)
    v_mfma_f32_32x32x16_bf16 v[112:127], a[140:143], v[88:91], v[112:127]
    v_mul_f32 v233, v233, v18
    v_cvt_pk_bf16_f32 v233, v233, v233
    v_and_b32 v233, 0xffff0000, v233
    s_waitcnt vmcnt(10)
    v_mfma_f32_32x32x16_bf16 v[144:159], a[140:143], v[92:95], v[144:159]
    ds_read_b128 a[152:155], v193 offset:0
    ds_read_b128 a[156:159], v193 offset:16384
    v_add_f32 v22, v233, v22
    v_and_b32 v23, 0xffff0000, v1
    v_sub_f32 v233, v23, v8
    v_mfma_f32_32x32x16_bf16 v[128:143], a[136:139], v[92:95], v[128:143]
    v_cvt_pk_bf16_f32 v233, v233, v233
    v_and_b32 v233, 0xffff0000, v233
    v_mul_f32 v234, v233, v232
    s_add_u32 s92, s30, 16384
    buffer_load_dwordx4 v[88:91], v219, s[24:27], s92 offen sc1
    s_waitcnt vmcnt(10) lgkmcnt(3)
    v_mfma_f32_32x32x16_bf16 v[96:111], a[144:147], v[48:51], v[96:111]
    s_add_u32 s92, s31, 16384
    buffer_load_dwordx4 v[92:95], v219, s[24:27], s92 offen sc1
    v_fma_f32 v233, -v234, v9, v233
    v_fma_f32 v233, v233, v232, v234
    v_cvt_pk_bf16_f32 v233, v233, v233
    s_waitcnt lgkmcnt(2)
    v_mfma_f32_32x32x16_bf16 v[112:127], a[148:151], v[48:51], v[112:127]
    v_and_b32 v233, 0xffff0000, v233
    v_mul_f32 v233, v233, v19
    v_cvt_pk_bf16_f32 v233, v233, v233
    s_waitcnt vmcnt(10)
    v_mfma_f32_32x32x16_bf16 v[144:159], a[148:151], v[52:55], v[144:159]
    ds_read_b128 a[128:131], v174 offset:32768
    ds_read_b128 a[132:135], v174 offset:49152
    v_and_b32 v233, 0xffff0000, v233
    v_add_f32 v23, v233, v23
    v_rcp_f32 v232, v11
    v_mfma_f32_32x32x16_bf16 v[128:143], a[144:147], v[52:55], v[128:143]
    v_lshlrev_b32 v24, 16, v2
    v_sub_f32 v233, v24, v10
    v_cvt_pk_bf16_f32 v233, v233, v233
    s_add_u32 s92, s54, 24576
    buffer_load_dwordx4 v[48:51], v213, s[24:27], s92 offen sc1
    s_waitcnt vmcnt(10) lgkmcnt(3)
    v_mfma_f32_32x32x16_bf16 v[96:111], a[152:155], v[56:59], v[96:111]
    s_add_u32 s92, s55, 24576
    buffer_load_dwordx4 v[52:55], v213, s[24:27], s92 offen sc1
    v_and_b32 v233, 0xffff0000, v233
    v_mul_f32 v234, v233, v232
    v_fma_f32 v233, -v234, v11, v233
    s_waitcnt lgkmcnt(2)
    v_mfma_f32_32x32x16_bf16 v[112:127], a[156:159], v[56:59], v[112:127]
    v_fma_f32 v233, v233, v232, v234
    v_cvt_pk_bf16_f32 v233, v233, v233
    v_and_b32 v233, 0xffff0000, v233
    s_waitcnt vmcnt(10)
    v_mfma_f32_32x32x16_bf16 v[144:159], a[156:159], v[60:63], v[144:159]
    ds_read_b128 a[136:139], v175 offset:32768
    ds_read_b128 a[140:143], v175 offset:49152
    v_mul_f32 v233, v233, v16
    v_cvt_pk_bf16_f32 v233, v233, v233
    v_and_b32 v233, 0xffff0000, v233
    v_mfma_f32_32x32x16_bf16 v[128:143], a[152:155], v[60:63], v[128:143]
    v_add_f32 v24, v233, v24
    v_and_b32 v25, 0xffff0000, v2
    v_sub_f32 v233, v25, v10
    s_add_u32 s92, s54, 24576
    buffer_load_dwordx4 v[56:59], v214, s[24:27], s92 offen sc1
    s_waitcnt vmcnt(10) lgkmcnt(3)
    v_mfma_f32_32x32x16_bf16 v[96:111], a[128:131], v[64:67], v[96:111]
    s_add_u32 s92, s55, 24576
    buffer_load_dwordx4 v[60:63], v214, s[24:27], s92 offen sc1
    v_cvt_pk_bf16_f32 v233, v233, v233
    v_and_b32 v233, 0xffff0000, v233
    v_mul_f32 v234, v233, v232
    s_waitcnt lgkmcnt(2)
    v_mfma_f32_32x32x16_bf16 v[112:127], a[132:135], v[64:67], v[112:127]
    v_fma_f32 v233, -v234, v11, v233
    v_fma_f32 v233, v233, v232, v234
    v_cvt_pk_bf16_f32 v233, v233, v233
    s_waitcnt vmcnt(10)
    v_mfma_f32_32x32x16_bf16 v[144:159], a[132:135], v[68:71], v[144:159]
    ds_read_b128 a[144:147], v209 offset:0
    ds_read_b128 a[148:151], v209 offset:16384
    v_and_b32 v233, 0xffff0000, v233
    v_mul_f32 v233, v233, v17
    v_cvt_pk_bf16_f32 v233, v233, v233
    v_mfma_f32_32x32x16_bf16 v[128:143], a[128:131], v[68:71], v[128:143]
    v_and_b32 v233, 0xffff0000, v233
    v_add_f32 v25, v233, v25
    v_lshlrev_b32 v26, 16, v3
    s_add_u32 s92, s54, 24576
    buffer_load_dwordx4 v[64:67], v215, s[24:27], s92 offen sc1
    s_waitcnt vmcnt(10) lgkmcnt(3)
    v_mfma_f32_32x32x16_bf16 v[96:111], a[136:139], v[72:75], v[96:111]
    s_add_u32 s92, s55, 24576
    buffer_load_dwordx4 v[68:71], v215, s[24:27], s92 offen sc1
    v_sub_f32 v233, v26, v10
    v_cvt_pk_bf16_f32 v233, v233, v233
    v_and_b32 v233, 0xffff0000, v233
    s_waitcnt lgkmcnt(2)
    v_mfma_f32_32x32x16_bf16 v[112:127], a[140:143], v[72:75], v[112:127]
    v_mul_f32 v234, v233, v232
    v_fma_f32 v233, -v234, v11, v233
    v_fma_f32 v233, v233, v232, v234
    s_waitcnt vmcnt(10)
    v_mfma_f32_32x32x16_bf16 v[144:159], a[140:143], v[76:79], v[144:159]
    ds_read_b128 a[152:155], v210 offset:0
    ds_read_b128 a[156:159], v210 offset:16384
    v_cvt_pk_bf16_f32 v233, v233, v233
    v_and_b32 v233, 0xffff0000, v233
    v_mul_f32 v233, v233, v18
    v_mfma_f32_32x32x16_bf16 v[128:143], a[136:139], v[76:79], v[128:143]
    v_cvt_pk_bf16_f32 v233, v233, v233
    v_and_b32 v233, 0xffff0000, v233
    v_add_f32 v26, v233, v26
    s_add_u32 s92, s54, 24576
    buffer_load_dwordx4 v[72:75], v219, s[24:27], s92 offen sc1
    s_waitcnt vmcnt(10) lgkmcnt(3)
    v_mfma_f32_32x32x16_bf16 v[96:111], a[144:147], v[80:83], v[96:111]
    s_add_u32 s92, s55, 24576
    buffer_load_dwordx4 v[76:79], v219, s[24:27], s92 offen sc1
    v_and_b32 v27, 0xffff0000, v3
    v_sub_f32 v233, v27, v10
    v_cvt_pk_bf16_f32 v233, v233, v233
    s_waitcnt lgkmcnt(2)
    v_mfma_f32_32x32x16_bf16 v[112:127], a[148:151], v[80:83], v[112:127]
    v_and_b32 v233, 0xffff0000, v233
    v_mul_f32 v234, v233, v232
    v_fma_f32 v233, -v234, v11, v233
    s_waitcnt vmcnt(10)
    v_mfma_f32_32x32x16_bf16 v[144:159], a[148:151], v[84:87], v[144:159]
    ds_read_b128 a[128:131], v180 offset:32768
    ds_read_b128 a[132:135], v180 offset:49152
    v_fma_f32 v233, v233, v232, v234
    v_cvt_pk_bf16_f32 v233, v233, v233
    v_and_b32 v233, 0xffff0000, v233
    v_mfma_f32_32x32x16_bf16 v[128:143], a[144:147], v[84:87], v[128:143]
    v_mul_f32 v233, v233, v19
    v_cvt_pk_bf16_f32 v233, v233, v233
    v_and_b32 v233, 0xffff0000, v233
    s_add_u32 s92, s30, 24576
    buffer_load_dwordx4 v[80:83], v213, s[24:27], s92 offen sc1
    s_waitcnt vmcnt(10) lgkmcnt(3)
    v_mfma_f32_32x32x16_bf16 v[96:111], a[152:155], v[88:91], v[96:111]
    s_add_u32 s92, s31, 24576
    buffer_load_dwordx4 v[84:87], v213, s[24:27], s92 offen sc1
    v_add_f32 v27, v233, v27
    v_rcp_f32 v232, v13
    v_lshlrev_b32 v28, 16, v4
    s_waitcnt lgkmcnt(2)
    v_mfma_f32_32x32x16_bf16 v[112:127], a[156:159], v[88:91], v[112:127]
    v_sub_f32 v233, v28, v12
    v_cvt_pk_bf16_f32 v233, v233, v233
    v_and_b32 v233, 0xffff0000, v233
    s_waitcnt vmcnt(10)
    v_mfma_f32_32x32x16_bf16 v[144:159], a[156:159], v[92:95], v[144:159]
    ds_read_b128 a[136:139], v193 offset:32768
    ds_read_b128 a[140:143], v193 offset:49152
    v_mul_f32 v234, v233, v232
    v_fma_f32 v233, -v234, v13, v233
    v_fma_f32 v233, v233, v232, v234
    v_mfma_f32_32x32x16_bf16 v[128:143], a[152:155], v[92:95], v[128:143]
    v_cvt_pk_bf16_f32 v233, v233, v233
    v_and_b32 v233, 0xffff0000, v233
    v_mul_f32 v233, v233, v16
    s_add_u32 s92, s30, 24576
    buffer_load_dwordx4 v[88:91], v214, s[24:27], s92 offen sc1
    s_waitcnt vmcnt(10) lgkmcnt(3)
    v_mfma_f32_32x32x16_bf16 v[96:111], a[128:131], v[48:51], v[96:111]
    s_add_u32 s92, s31, 24576
    buffer_load_dwordx4 v[92:95], v214, s[24:27], s92 offen sc1
    v_cvt_pk_bf16_f32 v233, v233, v233
    v_and_b32 v233, 0xffff0000, v233
    v_add_f32 v28, v233, v28
    s_waitcnt lgkmcnt(2)
    v_mfma_f32_32x32x16_bf16 v[112:127], a[132:135], v[48:51], v[112:127]
    v_and_b32 v29, 0xffff0000, v4
    v_sub_f32 v233, v29, v12
    v_cvt_pk_bf16_f32 v233, v233, v233
    s_waitcnt vmcnt(10)
    v_mfma_f32_32x32x16_bf16 v[144:159], a[132:135], v[52:55], v[144:159]
    ds_read_b128 a[144:147], v172 offset:0
    ds_read_b128 a[148:151], v172 offset:16384
    v_and_b32 v233, 0xffff0000, v233
    v_mul_f32 v234, v233, v232
    v_fma_f32 v233, -v234, v13, v233
    v_mfma_f32_32x32x16_bf16 v[128:143], a[128:131], v[52:55], v[128:143]
    v_fma_f32 v233, v233, v232, v234
    v_cvt_pk_bf16_f32 v233, v233, v233
    v_and_b32 v233, 0xffff0000, v233
    s_add_u32 s92, s30, 24576
    buffer_load_dwordx4 v[48:51], v215, s[24:27], s92 offen sc1
    s_waitcnt vmcnt(10) lgkmcnt(3)
    v_mfma_f32_32x32x16_bf16 v[96:111], a[136:139], v[56:59], v[96:111]
    s_add_u32 s92, s31, 24576
    buffer_load_dwordx4 v[52:55], v215, s[24:27], s92 offen sc1
    v_mul_f32 v233, v233, v17
    v_cvt_pk_bf16_f32 v233, v233, v233
    v_and_b32 v233, 0xffff0000, v233
    s_waitcnt lgkmcnt(2)
    v_mfma_f32_32x32x16_bf16 v[112:127], a[140:143], v[56:59], v[112:127]
    v_add_f32 v29, v233, v29
    v_lshlrev_b32 v30, 16, v5
    v_sub_f32 v233, v30, v12
    s_waitcnt vmcnt(10)
    v_mfma_f32_32x32x16_bf16 v[144:159], a[140:143], v[60:63], v[144:159]
    ds_read_b128 a[152:155], v173 offset:0
    ds_read_b128 a[156:159], v173 offset:16384
    v_cvt_pk_bf16_f32 v233, v233, v233
    v_and_b32 v233, 0xffff0000, v233
    v_mul_f32 v234, v233, v232
    v_mfma_f32_32x32x16_bf16 v[128:143], a[136:139], v[60:63], v[128:143]
    v_fma_f32 v233, -v234, v13, v233
    v_fma_f32 v233, v233, v232, v234
    v_cvt_pk_bf16_f32 v233, v233, v233
    s_add_u32 s92, s30, 24576
    buffer_load_dwordx4 v[56:59], v219, s[24:27], s92 offen sc1
    s_waitcnt vmcnt(10) lgkmcnt(3)
    v_mfma_f32_32x32x16_bf16 v[96:111], a[144:147], v[64:67], v[96:111]
    s_add_u32 s92, s31, 24576
    buffer_load_dwordx4 v[60:63], v219, s[24:27], s92 offen sc1
    v_and_b32 v233, 0xffff0000, v233
    v_mul_f32 v233, v233, v18
    v_cvt_pk_bf16_f32 v233, v233, v233
    s_waitcnt lgkmcnt(2)
    v_mfma_f32_32x32x16_bf16 v[112:127], a[148:151], v[64:67], v[112:127]
    v_and_b32 v233, 0xffff0000, v233
    v_add_f32 v30, v233, v30
    v_and_b32 v31, 0xffff0000, v5
    s_waitcnt vmcnt(10)
    v_mfma_f32_32x32x16_bf16 v[144:159], a[148:151], v[68:71], v[144:159]
    ds_read_b128 a[128:131], v209 offset:32768
    ds_read_b128 a[132:135], v209 offset:49152
    v_sub_f32 v233, v31, v12
    v_cvt_pk_bf16_f32 v233, v233, v233
    v_and_b32 v233, 0xffff0000, v233
    v_mfma_f32_32x32x16_bf16 v[128:143], a[144:147], v[68:71], v[128:143]
    v_mul_f32 v234, v233, v232
    v_fma_f32 v233, -v234, v13, v233
    v_fma_f32 v233, v233, v232, v234
    s_add_u32 s92, s54, 32768
    buffer_load_dwordx4 v[64:67], v213, s[24:27], s92 offen sc1
    s_waitcnt vmcnt(10) lgkmcnt(3)
    v_mfma_f32_32x32x16_bf16 v[96:111], a[152:155], v[72:75], v[96:111]
    s_add_u32 s92, s55, 32768
    buffer_load_dwordx4 v[68:71], v213, s[24:27], s92 offen sc1
    v_cvt_pk_bf16_f32 v233, v233, v233
    v_and_b32 v233, 0xffff0000, v233
    v_mul_f32 v233, v233, v19
    s_waitcnt lgkmcnt(2)
    v_mfma_f32_32x32x16_bf16 v[112:127], a[156:159], v[72:75], v[112:127]
    v_cvt_pk_bf16_f32 v233, v233, v233
    v_and_b32 v233, 0xffff0000, v233
    v_add_f32 v31, v233, v31
    s_waitcnt vmcnt(10)
    v_mfma_f32_32x32x16_bf16 v[144:159], a[156:159], v[76:79], v[144:159]
    ds_read_b128 a[136:139], v210 offset:32768
    ds_read_b128 a[140:143], v210 offset:49152
    v_rcp_f32 v232, v15
    v_lshlrev_b32 v32, 16, v6
    v_sub_f32 v233, v32, v14
    v_mfma_f32_32x32x16_bf16 v[128:143], a[152:155], v[76:79], v[128:143]
    v_cvt_pk_bf16_f32 v233, v233, v233
    v_and_b32 v233, 0xffff0000, v233
    v_mul_f32 v234, v233, v232
    s_add_u32 s92, s54, 32768
    buffer_load_dwordx4 v[72:75], v214, s[24:27], s92 offen sc1
    s_waitcnt vmcnt(10) lgkmcnt(3)
    v_mfma_f32_32x32x16_bf16 v[96:111], a[128:131], v[80:83], v[96:111]
    s_add_u32 s92, s55, 32768
    buffer_load_dwordx4 v[76:79], v214, s[24:27], s92 offen sc1
    v_fma_f32 v233, -v234, v15, v233
    v_fma_f32 v233, v233, v232, v234
    v_cvt_pk_bf16_f32 v233, v233, v233
    s_waitcnt lgkmcnt(2)
    v_mfma_f32_32x32x16_bf16 v[112:127], a[132:135], v[80:83], v[112:127]
    v_and_b32 v233, 0xffff0000, v233
    v_mul_f32 v233, v233, v16
    v_cvt_pk_bf16_f32 v233, v233, v233
    s_waitcnt vmcnt(10)
    v_mfma_f32_32x32x16_bf16 v[144:159], a[132:135], v[84:87], v[144:159]
    ds_read_b128 a[144:147], v174 offset:0
    ds_read_b128 a[148:151], v174 offset:16384
    v_and_b32 v233, 0xffff0000, v233
    v_add_f32 v32, v233, v32
    v_and_b32 v33, 0xffff0000, v6
    v_mfma_f32_32x32x16_bf16 v[128:143], a[128:131], v[84:87], v[128:143]
    v_sub_f32 v233, v33, v14
    v_cvt_pk_bf16_f32 v233, v233, v233
    v_and_b32 v233, 0xffff0000, v233
    s_add_u32 s92, s54, 32768
    buffer_load_dwordx4 v[80:83], v215, s[24:27], s92 offen sc1
    s_waitcnt vmcnt(10) lgkmcnt(3)
    v_mfma_f32_32x32x16_bf16 v[96:111], a[136:139], v[88:91], v[96:111]
    s_add_u32 s92, s55, 32768
    buffer_load_dwordx4 v[84:87], v215, s[24:27], s92 offen sc1
    v_mul_f32 v234, v233, v232
    v_fma_f32 v233, -v234, v15, v233
    v_fma_f32 v233, v233, v232, v234
    s_waitcnt lgkmcnt(2)
    v_mfma_f32_32x32x16_bf16 v[112:127], a[140:143], v[88:91], v[112:127]
    v_cvt_pk_bf16_f32 v233, v233, v233
    v_and_b32 v233, 0xffff0000, v233
    v_mul_f32 v233, v233, v17
    s_waitcnt vmcnt(10)
    v_mfma_f32_32x32x16_bf16 v[144:159], a[140:143], v[92:95], v[144:159]
    ds_read_b128 a[152:155], v175 offset:0
    ds_read_b128 a[156:159], v175 offset:16384
    v_cvt_pk_bf16_f32 v233, v233, v233
    v_and_b32 v233, 0xffff0000, v233
    v_add_f32 v33, v233, v33
    v_mfma_f32_32x32x16_bf16 v[128:143], a[136:139], v[92:95], v[128:143]
    v_lshlrev_b32 v34, 16, v7
    v_sub_f32 v233, v34, v14
    v_cvt_pk_bf16_f32 v233, v233, v233
    s_add_u32 s92, s54, 32768
    buffer_load_dwordx4 v[88:91], v219, s[24:27], s92 offen sc1
    s_waitcnt vmcnt(10) lgkmcnt(3)
    v_mfma_f32_32x32x16_bf16 v[96:111], a[144:147], v[48:51], v[96:111]
    s_add_u32 s92, s55, 32768
    buffer_load_dwordx4 v[92:95], v219, s[24:27], s92 offen sc1
    v_and_b32 v233, 0xffff0000, v233
    v_mul_f32 v234, v233, v232
    v_fma_f32 v233, -v234, v15, v233
    s_waitcnt lgkmcnt(2)
    v_mfma_f32_32x32x16_bf16 v[112:127], a[148:151], v[48:51], v[112:127]
    v_fma_f32 v233, v233, v232, v234
    v_cvt_pk_bf16_f32 v233, v233, v233
    v_and_b32 v233, 0xffff0000, v233
    s_waitcnt vmcnt(10)
    v_mfma_f32_32x32x16_bf16 v[144:159], a[148:151], v[52:55], v[144:159]
    v_mul_f32 v233, v233, v18
    v_cvt_pk_bf16_f32 v233, v233, v233
    v_and_b32 v233, 0xffff0000, v233
    v_mfma_f32_32x32x16_bf16 v[128:143], a[144:147], v[52:55], v[128:143]
    v_add_f32 v34, v233, v34
    v_and_b32 v35, 0xffff0000, v7
    v_sub_f32 v233, v35, v14
    s_add_u32 s92, s30, 32768
    buffer_load_dwordx4 v[48:51], v213, s[24:27], s92 offen sc1
    s_waitcnt vmcnt(10) lgkmcnt(1)
    v_mfma_f32_32x32x16_bf16 v[96:111], a[152:155], v[56:59], v[96:111]
    s_add_u32 s92, s31, 32768
    buffer_load_dwordx4 v[52:55], v213, s[24:27], s92 offen sc1
    v_cvt_pk_bf16_f32 v233, v233, v233
    v_and_b32 v233, 0xffff0000, v233
    v_mul_f32 v234, v233, v232
    s_waitcnt lgkmcnt(0)
    v_mfma_f32_32x32x16_bf16 v[112:127], a[156:159], v[56:59], v[112:127]
    v_fma_f32 v233, -v234, v15, v233
    v_fma_f32 v233, v233, v232, v234
    v_cvt_pk_bf16_f32 v233, v233, v233
    s_waitcnt vmcnt(10)
    v_mfma_f32_32x32x16_bf16 v[144:159], a[156:159], v[60:63], v[144:159]
    v_and_b32 v233, 0xffff0000, v233
    v_mul_f32 v233, v233, v19
    v_cvt_pk_bf16_f32 v233, v233, v233
    v_mfma_f32_32x32x16_bf16 v[128:143], a[152:155], v[60:63], v[128:143]
    v_and_b32 v233, 0xffff0000, v233
    v_add_f32 v35, v233, v35
    s_lshl_b32 s60, s60, 1
    s_add_u32 s92, s30, 32768
    buffer_load_dwordx4 v[56:59], v214, s[24:27], s92 offen sc1
    s_waitcnt vmcnt(10)
    v_mfma_f32_32x32x16_bf16 v[96:111], a[32:35], v[64:67], v[96:111]
    s_add_u32 s92, s31, 32768
    buffer_load_dwordx4 v[60:63], v214, s[24:27], s92 offen sc1
    v_mfma_f32_32x32x16_bf16 v[112:127], a[36:39], v[64:67], v[112:127]
    s_waitcnt vmcnt(10)
    v_mfma_f32_32x32x16_bf16 v[144:159], a[36:39], v[68:71], v[144:159]
    v_mfma_f32_32x32x16_bf16 v[128:143], a[32:35], v[68:71], v[128:143]
    s_add_u32 s92, s30, 32768
    buffer_load_dwordx4 v[64:67], v215, s[24:27], s92 offen sc1
    s_waitcnt vmcnt(10)
    v_mfma_f32_32x32x16_bf16 v[96:111], a[40:43], v[72:75], v[96:111]
    s_add_u32 s92, s31, 32768
    buffer_load_dwordx4 v[68:71], v215, s[24:27], s92 offen sc1
    v_mfma_f32_32x32x16_bf16 v[112:127], a[44:47], v[72:75], v[112:127]
    s_waitcnt vmcnt(10)
    v_mfma_f32_32x32x16_bf16 v[144:159], a[44:47], v[76:79], v[144:159]
    v_mfma_f32_32x32x16_bf16 v[128:143], a[40:43], v[76:79], v[128:143]
    s_add_u32 s92, s30, 32768
    buffer_load_dwordx4 v[72:75], v219, s[24:27], s92 offen sc1
    s_waitcnt vmcnt(10)
    v_mfma_f32_32x32x16_bf16 v[96:111], a[48:51], v[80:83], v[96:111]
    s_add_u32 s92, s31, 32768
    buffer_load_dwordx4 v[76:79], v219, s[24:27], s92 offen sc1
    v_mfma_f32_32x32x16_bf16 v[112:127], a[52:55], v[80:83], v[112:127]
    s_waitcnt vmcnt(10)
    v_mfma_f32_32x32x16_bf16 v[144:159], a[52:55], v[84:87], v[144:159]
    v_mfma_f32_32x32x16_bf16 v[128:143], a[48:51], v[84:87], v[128:143]
    s_add_u32 s92, s54, 40960
    s_sub_u32 s92, s92, s58
    buffer_load_dwordx4 v[80:83], v213, s[24:27], s92 offen sc1
    s_waitcnt vmcnt(10)
    v_mfma_f32_32x32x16_bf16 v[96:111], a[56:59], v[88:91], v[96:111]
    s_add_u32 s92, s55, 40960
    s_sub_u32 s92, s92, s58
    buffer_load_dwordx4 v[84:87], v213, s[24:27], s92 offen sc1
    v_mfma_f32_32x32x16_bf16 v[112:127], a[60:63], v[88:91], v[112:127]
    s_waitcnt vmcnt(10)
    v_mfma_f32_32x32x16_bf16 v[144:159], a[60:63], v[92:95], v[144:159]
    v_mfma_f32_32x32x16_bf16 v[128:143], a[56:59], v[92:95], v[128:143]
    s_add_u32 s92, s55, 40960
    s_sub_u32 s92, s92, s58
    buffer_load_dwordx4 v[92:95], v214, s[24:27], s92 offen sc1
    s_waitcnt vmcnt(10)
    v_mfma_f32_32x32x16_bf16 v[96:111], a[64:67], v[48:51], v[96:111]
    v_mfma_f32_32x32x16_bf16 v[112:127], a[68:71], v[48:51], v[112:127]
    s_waitcnt vmcnt(9)
    v_mfma_f32_32x32x16_bf16 v[144:159], a[68:71], v[52:55], v[144:159]
    v_mfma_f32_32x32x16_bf16 v[128:143], a[64:67], v[52:55], v[128:143]
    s_add_u32 s92, s55, 40960
    s_sub_u32 s92, s92, s58
    buffer_load_dwordx4 v[52:55], v215, s[24:27], s92 offen sc1
    s_waitcnt vmcnt(9)
    v_mfma_f32_32x32x16_bf16 v[96:111], a[72:75], v[56:59], v[96:111]
    v_mfma_f32_32x32x16_bf16 v[112:127], a[76:79], v[56:59], v[112:127]
    s_waitcnt vmcnt(8)
    v_mfma_f32_32x32x16_bf16 v[144:159], a[76:79], v[60:63], v[144:159]
    v_mfma_f32_32x32x16_bf16 v[128:143], a[72:75], v[60:63], v[128:143]
    s_add_u32 s92, s55, 40960
    s_sub_u32 s92, s92, s58
    buffer_load_dwordx4 v[60:63], v219, s[24:27], s92 offen sc1
    s_waitcnt vmcnt(8)
    v_mfma_f32_32x32x16_bf16 v[96:111], a[80:83], v[64:67], v[96:111]
    s_add_u32 s92, s54, 40960
    s_sub_u32 s92, s92, s58
    buffer_load_dwordx4 v[88:91], v214, s[24:27], s92 offen sc1
    v_mfma_f32_32x32x16_bf16 v[112:127], a[84:87], v[64:67], v[112:127]
    s_add_u32 s92, s54, 40960
    s_sub_u32 s92, s92, s58
    buffer_load_dwordx4 v[48:51], v215, s[24:27], s92 offen sc1
    s_waitcnt vmcnt(9)
    v_mfma_f32_32x32x16_bf16 v[144:159], a[84:87], v[68:71], v[144:159]
    s_add_u32 s92, s54, 40960
    s_sub_u32 s92, s92, s58
    buffer_load_dwordx4 v[56:59], v219, s[24:27], s92 offen sc1
    v_mfma_f32_32x32x16_bf16 v[128:143], a[80:83], v[68:71], v[128:143]
    s_waitcnt vmcnt(9)
    v_mfma_f32_32x32x16_bf16 v[96:111], a[88:91], v[72:75], v[96:111]
    v_mfma_f32_32x32x16_bf16 v[112:127], a[92:95], v[72:75], v[112:127]
    s_waitcnt vmcnt(8)
    v_mfma_f32_32x32x16_bf16 v[144:159], a[92:95], v[76:79], v[144:159]
    v_mfma_f32_32x32x16_bf16 v[128:143], a[88:91], v[76:79], v[128:143]
    s_waitcnt vmcnt(7)
    v_mfma_f32_32x32x16_bf16 v[96:111], a[96:99], v[80:83], v[96:111]
    v_mfma_f32_32x32x16_bf16 v[112:127], a[100:103], v[80:83], v[112:127]
    s_waitcnt vmcnt(6)
    v_mfma_f32_32x32x16_bf16 v[144:159], a[100:103], v[84:87], v[144:159]
    v_mfma_f32_32x32x16_bf16 v[128:143], a[96:99], v[84:87], v[128:143]
    s_waitcnt vmcnt(5)
    v_mfma_f32_32x32x16_bf16 v[144:159], a[108:111], v[92:95], v[144:159]
    s_waitcnt vmcnt(4)
    v_mfma_f32_32x32x16_bf16 v[144:159], a[116:119], v[52:55], v[144:159]
    s_waitcnt vmcnt(3)
    v_mfma_f32_32x32x16_bf16 v[144:159], a[124:127], v[60:63], v[144:159]
    v_mfma_f32_32x32x16_bf16 v[128:143], a[104:107], v[92:95], v[128:143]
    v_mfma_f32_32x32x16_bf16 v[128:143], a[112:115], v[52:55], v[128:143]
    v_mfma_f32_32x32x16_bf16 v[128:143], a[120:123], v[60:63], v[128:143]
    s_nop 8
    ds_write_b128 v185, v[144:147] offset:49152
    ds_write_b128 v186, v[148:151] offset:49152
    ds_write_b128 v187, v[152:155] offset:49152
    ds_write_b128 v188, v[156:159] offset:49152
    ds_write_b128 v185, v[128:131] offset:32768
    ds_write_b128 v186, v[132:135] offset:32768
    ds_write_b128 v187, v[136:139] offset:32768
    ds_write_b128 v188, v[140:143] offset:32768
    s_waitcnt vmcnt(2)
    v_mfma_f32_32x32x16_bf16 v[112:127], a[108:111], v[88:91], v[112:127]
    v_mfma_f32_32x32x16_bf16 v[96:111], a[104:107], v[88:91], v[96:111]
    s_waitcnt vmcnt(1)
    v_mfma_f32_32x32x16_bf16 v[112:127], a[116:119], v[48:51], v[112:127]
    v_mfma_f32_32x32x16_bf16 v[96:111], a[112:115], v[48:51], v[96:111]
    s_waitcnt vmcnt(0)
    v_mfma_f32_32x32x16_bf16 v[112:127], a[124:127], v[56:59], v[112:127]
    v_mfma_f32_32x32x16_bf16 v[96:111], a[120:123], v[56:59], v[96:111]
Lmark3:
    s_nop 10
    ds_write_b128 v185, v[112:115] offset:16384
    ds_write_b128 v186, v[116:119] offset:16384
    ds_write_b128 v187, v[120:123] offset:16384
    ds_write_b128 v188, v[124:127] offset:16384
    ds_write_b128 v185, v[96:99] offset:0
    ds_write_b128 v186, v[100:103] offset:0
    ds_write_b128 v187, v[104:107] offset:0
    ds_write_b128 v188, v[108:111] offset:0
    s_waitcnt lgkmcnt(0)
    s_barrier
    ds_read_b128 v[128:131], v238 offset:32768
    ds_read_b128 v[132:135], v239 offset:49152
    ds_read_b128 v[136:139], v238 offset:33792
    ds_read_b128 v[140:143], v239 offset:50176
    ds_read_b128 v[144:147], v238 offset:34816
    ds_read_b128 v[148:151], v239 offset:51200
    ds_read_b128 v[152:155], v238 offset:35840
    ds_read_b128 v[156:159], v239 offset:52224
    s_waitcnt lgkmcnt(6)
    v_pk_add_f32 v[128:129], v[128:129], v[132:133]
    v_pk_add_f32 v[130:131], v[130:131], v[134:135]
    v_pk_add_f32 v[20:21], v[20:21], v[128:129]
    v_pk_add_f32 v[22:23], v[22:23], v[130:131]
    s_waitcnt lgkmcnt(4)
    v_pk_add_f32 v[136:137], v[136:137], v[140:141]
    v_pk_add_f32 v[138:139], v[138:139], v[142:143]
    v_pk_add_f32 v[24:25], v[24:25], v[136:137]
    v_pk_add_f32 v[26:27], v[26:27], v[138:139]
    s_waitcnt lgkmcnt(2)
    v_pk_add_f32 v[144:145], v[144:145], v[148:149]
    v_pk_add_f32 v[146:147], v[146:147], v[150:151]
    v_pk_add_f32 v[28:29], v[28:29], v[144:145]
    v_pk_add_f32 v[30:31], v[30:31], v[146:147]
    s_waitcnt lgkmcnt(0)
    v_pk_add_f32 v[152:153], v[152:153], v[156:157]
    v_pk_add_f32 v[154:155], v[154:155], v[158:159]
    v_pk_add_f32 v[32:33], v[32:33], v[152:153]
    v_pk_add_f32 v[34:35], v[34:35], v[154:155]
    ds_read_b128 v[128:131], v236 offset:0
    ds_read_b128 v[132:135], v237 offset:16384
    ds_read_b128 v[136:139], v236 offset:1024
    ds_read_b128 v[140:143], v237 offset:17408
    ds_read_b128 v[144:147], v236 offset:2048
    ds_read_b128 v[148:151], v237 offset:18432
    ds_read_b128 v[152:155], v236 offset:3072
    ds_read_b128 v[156:159], v237 offset:19456
    s_waitcnt lgkmcnt(6)
    v_pk_add_f32 v[128:129], v[128:129], v[132:133]
    v_pk_add_f32 v[130:131], v[130:131], v[134:135]
    v_pk_add_f32 v[20:21], v[20:21], v[128:129]
    v_pk_add_f32 v[22:23], v[22:23], v[130:131]
    s_add_u32 s67, s60, 0
    buffer_store_dwordx4 v[20:23], v182, s[44:47], s67 offen
    s_waitcnt lgkmcnt(4)
    v_pk_add_f32 v[136:137], v[136:137], v[140:141]
    v_pk_add_f32 v[138:139], v[138:139], v[142:143]
    v_pk_add_f32 v[24:25], v[24:25], v[136:137]
    v_pk_add_f32 v[26:27], v[26:27], v[138:139]
    s_add_u32 s67, s60, 8192
    buffer_store_dwordx4 v[24:27], v182, s[44:47], s67 offen
    s_waitcnt lgkmcnt(2)
    v_pk_add_f32 v[144:145], v[144:145], v[148:149]
    v_pk_add_f32 v[146:147], v[146:147], v[150:151]
    v_pk_add_f32 v[28:29], v[28:29], v[144:145]
    v_pk_add_f32 v[30:31], v[30:31], v[146:147]
    s_add_u32 s67, s60, 16384
    buffer_store_dwordx4 v[28:31], v182, s[44:47], s67 offen
    s_waitcnt lgkmcnt(0)
    v_pk_add_f32 v[152:153], v[152:153], v[156:157]
    v_pk_add_f32 v[154:155], v[154:155], v[158:159]
    v_pk_add_f32 v[32:33], v[32:33], v[152:153]
    v_pk_add_f32 v[34:35], v[34:35], v[154:155]
    s_add_u32 s67, s60, 24576
    buffer_store_dwordx4 v[32:35], v182, s[44:47], s67 offen
k_exit:
    s_endpgm
k_main_end:
Lretry0:
    s_mov_b32 s101, 0
Lspin0:
    s_sleep 4
    s_add_u32 s101, s101, 1
    s_cmp_gt_u32 s101, 2097152
    s_cbranch_scc1 Lback0
    buffer_load_dword v246, v245, s[24:27], s49 offen sc1
    s_waitcnt vmcnt(0)
    v_cmp_ne_u32 vcc, s99, v246
    s_nop 4
    s_cbranch_vccnz Lspin0
    s_branch Lback0
Lretry1:
    s_mov_b32 s101, 0
Lspin1:
    s_sleep 8
    s_add_u32 s101, s101, 1
    s_cmp_gt_u32 s101, 2097152
    s_cbranch_scc1 Lback1
    buffer_load_dword v246, v245, s[24:27], s79 offen sc1
    s_waitcnt vmcnt(0)
    v_cmp_ne_u32 vcc, s80, v246
    s_nop 4
    s_cbranch_vccnz Lspin1
    s_branch Lback1
Lretry2:
    s_mov_b32 s101, 0
Lspin2:
    s_sleep 2
    s_add_u32 s101, s101, 1
    s_cmp_gt_u32 s101, 2097152
    s_cbranch_scc1 Lback2
    buffer_load_dwordx4 v[32:35], v212, s[32:35], 0 offen offset:1024 sc1
    buffer_load_dwordx4 v[36:39], v212, s[32:35], 0 offen offset:0 sc1
    s_waitcnt vmcnt(0)
    v_add_u32 v240, v33, v35
    v_add3_u32 v240, v240, v37, v39
    v_cmp_ne_u32 vcc, v211, v240
    s_nop 4
    s_cbranch_vccnz Lspin2
    s_branch Lback2
Lretry3:
    s_mov_b32 s101, 0
Lspin3:
    s_sleep 4
    s_add_u32 s101, s101, 1
    s_cmp_gt_u32 s101, 2097152
    s_cbranch_scc1 Lback3
    buffer_load_dword v246, v244, s[24:27], s3 offen sc1
    s_waitcnt vmcnt(0)
    v_cmp_ne_u32 vcc, s99, v246
    s_nop 4
    s_cbranch_vccnz Lspin3
    s_branch Lback3
Lretry4:
    s_mov_b32 s101, 0
Lspin4:
    s_sleep 4
    s_add_u32 s101, s101, 1
    s_cmp_gt_u32 s101, 2097152
    s_cbranch_scc1 Lback4
    buffer_load_dword v246, v244, s[24:27], s3 offen sc1
    s_waitcnt vmcnt(0)
    v_cmp_ne_u32 vcc, s99, v246
    s_nop 4
    s_cbranch_vccnz Lspin4
    s_branch Lback4
    s_endpgm
k_all_end:
.section .rodata,"a"
.p2align 6
.amdhsa_kernel parallel_sum__ssm_conv_s5__glu_gated_glu__prompt_kernel
  .amdhsa_next_free_vgpr 512
  .amdhsa_next_free_sgpr 102
  .amdhsa_accum_offset 256
  .amdhsa_group_segment_fixed_size 0
  .amdhsa_kernarg_size 128
  .amdhsa_user_sgpr_count 2
  .amdhsa_user_sgpr_kernarg_segment_ptr 1
  .amdhsa_system_sgpr_workgroup_id_x 1
.end_amdhsa_kernel
```
